```python
import torch

def _softmax(x, axis=-1):
    return torch.softmax(x, dim=axis)
def _gelu(x):
    return torch.nn.functional.gelu(x, approximate="tanh")
def _silu(x):
    return torch.nn.functional.silu(x)
def _sigmoid(x):
    return torch.sigmoid(x)
def _layernorm(x, axis=-1, eps=1e-5):
    m = x.mean(dim=axis, keepdim=True)
    v = x.var(dim=axis, keepdim=True, unbiased=False)
    return (x - m) / torch.sqrt(v + eps)
def _scatter_add(tgt, idx, src, axis=0):
    return tgt.clone().index_add_(axis, idx, src)
def _segment_sum(src, seg, n):
    out = torch.zeros((n,) + src.shape[1:], dtype=src.dtype)
    return out.index_add_(0, seg, src)
def _pad(x, pw):
    flat = tuple(v for pair in reversed(pw) for v in pair)
    return torch.nn.functional.pad(x, flat)

kernel_name = 'standalone__dense_activation_gelu__prompt'

def setup_inputs():

    _w = (lambda a: (lambda t: t.to(torch.bfloat16) if t.is_floating_point() else t)(torch.as_tensor(a)))
    B, S, D, F = 1, 2048, 640, 1728
    return {
        "x": _w((lambda *s: torch.randn(*s, dtype=torch.bfloat16) * 0.05)(B, S, D)),
        "w1": _w((lambda *s: torch.randn(*s, dtype=torch.bfloat16) * 3.2)(D, F) * (D ** -0.5)),
        "b1": _w((lambda *s: torch.randn(*s, dtype=torch.bfloat16) * 3.2)(F) * 0.01),
        "w2": _w((lambda *s: torch.randn(*s, dtype=torch.bfloat16) * 0.05)(F, D) * (F ** -0.5)),
        "b2": _w((lambda *s: torch.randn(*s, dtype=torch.bfloat16) * 0.1)(D) * 0.01),
    }

def reference(x, w1, b1, w2, b2):
    h = torch.einsum("bsd,df->bsf", x, w1) + b1
    h = _gelu(h)
    return torch.einsum("bsf,fd->bsd", h, w2) + b2
```

```asm
; @launch grid=(256,1,1) block=(256,1,1) lds=163840
.amdgcn_target "amdgcn-amd-amdhsa--gfx950"
.text
.globl standalone__dense_activation_gelu__prompt_kernel
.p2align 8
.type standalone__dense_activation_gelu__prompt_kernel,@function
standalone__dense_activation_gelu__prompt_kernel:
    s_load_dwordx2 s[20:21], s[0:1], 0
    s_load_dwordx2 s[24:25], s[0:1], 8
    s_load_dwordx2 s[28:29], s[0:1], 16
    s_cmp_lt_u32 s2, 224
    s_cbranch_scc1 L_active
    s_cmp_lt_u32 s2, 256
    s_cbranch_scc1 L_idle
    s_endpgm
L_active:
    s_mov_b32 s22, 2621440
    s_mov_b32 s23, 0x20000
    s_mov_b32 s26, 2211840
    s_mov_b32 s27, 0x20000
    v_lshrrev_b32 v2, 6, v0
    v_and_b32 v1, 63, v0
    v_readfirstlane_b32 s56, v2
    s_and_b32 s73, s2, 7
    s_lshr_b32 s72, s2, 3
    s_lshl_b32 s57, s56, 12
    s_lshr_b32 s58, s73, 1
    s_and_b32 s62, s72, 3
    s_lshl2_add_u32 s58, s58, s62
    s_and_b32 s59, s73, 1
    s_mul_i32 s59, s59, 7
    s_lshr_b32 s63, s72, 2
    s_add_u32 s59, s59, s63
    s_mul_i32 s62, s62, 10
    s_mul_i32 s63, s63, 6
    s_add_u32 s62, s62, s63
    s_lshr_b32 s62, s62, 2
    s_sub_u32 s63, s62, 10
    s_min_u32 s62, s62, s63
    s_lshl_b32 s60, s62, 7
    s_mul_i32 s61, s62, 221184
    s_lshl2_add_u32 s62, s58, s56
    s_mul_i32 s62, s62, 40960
    s_mul_i32 s63, s56, 55296
    s_lshl_b32 s64, s59, 8
    s_add_u32 s63, s63, s64
    s_sub_u32 s64, 3456, s64
    v_lshrrev_b32 v2, 3, v1
    v_and_b32 v3, 7, v1
    v_lshrrev_b32 v4, 1, v2
    v_xor_b32 v3, v3, v4
    v_lshlrev_b32 v3, 4, v3
    v_mul_u32_u24 v2, 1280, v2
    v_add3_u32 v10, v2, v3, s62
    v_xor_b32 v11, 64, v10
    v_add_u32 v11, 9216, v11
    v_add_u32 v12, 18432, v10
    v_add_u32 v13, 18432, v11
    v_lshrrev_b32 v2, 4, v1
    v_and_b32 v3, 15, v1
    v_lshlrev_b32 v4, 1, v2
    v_xor_b32 v3, v3, v4
    v_lshlrev_b32 v3, 4, v3
    v_xor_b32 v5, 0x80, v3
    v_mul_u32_u24 v2, 3456, v2
    v_mov_b32 v4, 1073741824
    v_cmp_gt_u32 vcc, s64, v3
    v_add3_u32 v14, v2, v3, s63
    v_add3_u32 v16, v2, v5, s63
    v_cndmask_b32 v14, v4, v14, vcc
    v_cmp_gt_u32 vcc, s64, v5
    v_add_u32 v15, 12800, v14
    s_lshr_b32 s65, s56, 1
    v_cndmask_b32 v16, v4, v16, vcc
    v_add_u32 v17, 38400, v16
    v_add_u32 v16, 25600, v16
    s_waitcnt lgkmcnt(0)
    s_add_u32 m0, s57, 0
    s_nop 0
    buffer_load_dwordx4 v10, s[20:23], s60 offen offset:0 lds
    buffer_load_dwordx4 v11, s[20:23], s60 offen offset:1024 lds
    buffer_load_dwordx4 v12, s[20:23], s60 offen offset:2048 lds
    buffer_load_dwordx4 v13, s[20:23], s60 offen offset:3072 lds
    s_add_u32 m0, s57, 16384
    s_nop 0
    buffer_load_dwordx4 v14, s[24:27], s61 offen offset:0 lds
    buffer_load_dwordx4 v15, s[24:27], s61 offen offset:1024 lds
    buffer_load_dwordx4 v16, s[24:27], s61 offen offset:2048 lds
    buffer_load_dwordx4 v17, s[24:27], s61 offen offset:3072 lds
    s_add_u32 s60, s60, 128
    s_add_u32 s61, s61, 221184
    s_cmp_eq_u32 s60, 1280
    s_cselect_b32 s60, 0, s60
    s_cselect_b32 s61, 0, s61
    s_mov_b32 s30, 3456
    s_mov_b32 s31, 0x20000
    s_lshl1_add_u32 s65, s59, s65
    s_lshl_b32 s65, s65, 7
    v_lshrrev_b32 v2, 4, v1
    v_lshl_add_u32 v41, v2, 3, s65
    buffer_load_dwordx2 v[144:145], v41, s[28:31], 0 offen offset:0
    buffer_load_dwordx2 v[146:147], v41, s[28:31], 0 offen offset:32
    buffer_load_dwordx2 v[148:149], v41, s[28:31], 0 offen offset:64
    buffer_load_dwordx2 v[150:151], v41, s[28:31], 0 offen offset:96
    s_load_dwordx2 s[32:33], s[0:1], 24
    s_load_dwordx2 s[36:37], s[0:1], 32
    s_load_dwordx2 s[40:41], s[0:1], 40
    s_load_dwordx2 s[44:45], s[0:1], 48
    s_load_dwordx2 s[48:49], s[0:1], 56
    s_sub_u32 s62, s72, 0
    s_lshl2_add_u32 s62, s62, s56
    s_mov_b64 exec, 0
    s_cmpk_eq_u32 s56, 1
    s_cbranch_scc1 L_hqA1
    s_cmpk_eq_u32 s56, 2
    s_cbranch_scc1 L_hqA2
    s_cmpk_eq_u32 s56, 3
    s_cbranch_scc1 L_hqA3
L_hqA0:
    s_cmpk_eq_u32 s62, 0
    s_cbranch_scc1 L_hpA0
    s_cmpk_eq_u32 s62, 4
    s_cbranch_scc1 L_hpA4
    s_cmpk_eq_u32 s62, 8
    s_cbranch_scc1 L_hpA8
    s_cmpk_eq_u32 s62, 12
    s_cbranch_scc1 L_hpA12
    s_cmpk_eq_u32 s62, 16
    s_cbranch_scc1 L_hpA16
    s_cmpk_eq_u32 s62, 20
    s_cbranch_scc1 L_hpA20
    s_cmpk_eq_u32 s62, 24
    s_cbranch_scc1 L_hpA24
    s_cmpk_eq_u32 s62, 28
    s_cbranch_scc1 L_hpA28
    s_cmpk_eq_u32 s62, 32
    s_cbranch_scc1 L_hpA32
    s_cmpk_eq_u32 s62, 36
    s_cbranch_scc1 L_hpA36
    s_cmpk_eq_u32 s62, 40
    s_cbranch_scc1 L_hpA40
    s_cmpk_eq_u32 s62, 44
    s_cbranch_scc1 L_hpA44
    s_branch L_hpA_back0
L_hqA1:
    s_cmpk_eq_u32 s62, 1
    s_cbranch_scc1 L_hpA1
    s_cmpk_eq_u32 s62, 5
    s_cbranch_scc1 L_hpA5
    s_cmpk_eq_u32 s62, 9
    s_cbranch_scc1 L_hpA9
    s_cmpk_eq_u32 s62, 13
    s_cbranch_scc1 L_hpA13
    s_cmpk_eq_u32 s62, 17
    s_cbranch_scc1 L_hpA17
    s_cmpk_eq_u32 s62, 21
    s_cbranch_scc1 L_hpA21
    s_cmpk_eq_u32 s62, 25
    s_cbranch_scc1 L_hpA25
    s_cmpk_eq_u32 s62, 29
    s_cbranch_scc1 L_hpA29
    s_cmpk_eq_u32 s62, 33
    s_cbranch_scc1 L_hpA33
    s_cmpk_eq_u32 s62, 37
    s_cbranch_scc1 L_hpA37
    s_cmpk_eq_u32 s62, 41
    s_cbranch_scc1 L_hpA41
    s_branch L_hpA_back0
L_hqA2:
    s_cmpk_eq_u32 s62, 2
    s_cbranch_scc1 L_hpA2
    s_cmpk_eq_u32 s62, 6
    s_cbranch_scc1 L_hpA6
    s_cmpk_eq_u32 s62, 10
    s_cbranch_scc1 L_hpA10
    s_cmpk_eq_u32 s62, 14
    s_cbranch_scc1 L_hpA14
    s_cmpk_eq_u32 s62, 18
    s_cbranch_scc1 L_hpA18
    s_cmpk_eq_u32 s62, 22
    s_cbranch_scc1 L_hpA22
    s_cmpk_eq_u32 s62, 26
    s_cbranch_scc1 L_hpA26
    s_cmpk_eq_u32 s62, 30
    s_cbranch_scc1 L_hpA30
    s_cmpk_eq_u32 s62, 34
    s_cbranch_scc1 L_hpA34
    s_cmpk_eq_u32 s62, 38
    s_cbranch_scc1 L_hpA38
    s_cmpk_eq_u32 s62, 42
    s_cbranch_scc1 L_hpA42
    s_branch L_hpA_back0
L_hqA3:
    s_cmpk_eq_u32 s62, 3
    s_cbranch_scc1 L_hpA3
    s_cmpk_eq_u32 s62, 7
    s_cbranch_scc1 L_hpA7
    s_cmpk_eq_u32 s62, 11
    s_cbranch_scc1 L_hpA11
    s_cmpk_eq_u32 s62, 15
    s_cbranch_scc1 L_hpA15
    s_cmpk_eq_u32 s62, 19
    s_cbranch_scc1 L_hpA19
    s_cmpk_eq_u32 s62, 23
    s_cbranch_scc1 L_hpA23
    s_cmpk_eq_u32 s62, 27
    s_cbranch_scc1 L_hpA27
    s_cmpk_eq_u32 s62, 31
    s_cbranch_scc1 L_hpA31
    s_cmpk_eq_u32 s62, 35
    s_cbranch_scc1 L_hpA35
    s_cmpk_eq_u32 s62, 39
    s_cbranch_scc1 L_hpA39
    s_cmpk_eq_u32 s62, 43
    s_cbranch_scc1 L_hpA43
L_hpA_back0:
L_hpA_done:
    s_mov_b64 exec, -1
    s_and_b32 s62, s56, 1
    s_lshr_b32 s63, s56, 1
    s_lshl_b32 s64, s62, 13
    v_and_b32 v2, 15, v1
    v_lshrrev_b32 v3, 4, v1
    v_bfe_u32 v4, v1, 1, 3
    v_lshlrev_b32 v2, 7, v2
    v_xor_b32 v4, v3, v4
    v_lshl_add_u32 v2, v4, 4, v2
    v_add_u32 v22, s64, v2
    v_xor_b32 v23, 64, v22
    v_bfe_u32 v2, v1, 2, 2
    v_lshl_add_u32 v4, v3, 3, v2
    v_lshlrev_b32 v4, 8, v4
    v_and_b32 v5, 3, v1
    v_lshl_add_u32 v4, v5, 3, v4
    v_and_b32 v5, 1, v3
    v_xor_b32 v5, s63, v5
    v_lshl_add_u32 v2, v5, 2, v2
    v_lshl_add_u32 v2, v2, 5, v4
    v_add_u32 v28, 16384, v2
    v_xor_b32 v29, 32, v28
    v_xor_b32 v30, 64, v28
    v_xor_b32 v31, 96, v28
    s_mov_b64 exec, 0
    s_cmpk_eq_u32 s56, 0
    s_cbranch_scc1 L_pg0
    s_cmpk_eq_u32 s56, 1
    s_cbranch_scc1 L_pg1
    s_cmpk_eq_u32 s56, 2
    s_cbranch_scc1 L_pg2
    s_cmpk_eq_u32 s56, 3
    s_cbranch_scc1 L_pg3
L_pg_back:
    s_mov_b64 exec, -1
    s_add_u32 m0, s57, 32768
    s_nop 0
    buffer_load_dwordx4 v10, s[20:23], s60 offen offset:0 lds
    buffer_load_dwordx4 v11, s[20:23], s60 offen offset:1024 lds
    buffer_load_dwordx4 v12, s[20:23], s60 offen offset:2048 lds
    buffer_load_dwordx4 v13, s[20:23], s60 offen offset:3072 lds
    s_add_u32 m0, s57, 49152
    s_nop 0
    buffer_load_dwordx4 v14, s[24:27], s61 offen offset:0 lds
    buffer_load_dwordx4 v15, s[24:27], s61 offen offset:1024 lds
    buffer_load_dwordx4 v16, s[24:27], s61 offen offset:2048 lds
    buffer_load_dwordx4 v17, s[24:27], s61 offen offset:3072 lds
    s_add_u32 s60, s60, 128
L_hpA0:
    s_cbranch_execz L_hpA_back0
    s_add_u32 s61, s61, 221184
    s_cmp_eq_u32 s60, 1280
    s_cselect_b32 s60, 0, s60
    s_cselect_b32 s61, 0, s61
    s_waitcnt vmcnt(11)
    v_lshlrev_b32 v128, 16, v144
    v_and_b32 v129, 0xffff0000, v144
    v_lshlrev_b32 v130, 16, v145
    v_and_b32 v131, 0xffff0000, v145
    s_waitcnt vmcnt(10)
    v_lshlrev_b32 v132, 16, v146
    v_and_b32 v133, 0xffff0000, v146
    v_lshlrev_b32 v134, 16, v147
    v_and_b32 v135, 0xffff0000, v147
    s_waitcnt vmcnt(9)
    v_lshlrev_b32 v136, 16, v148
    v_and_b32 v137, 0xffff0000, v148
    v_lshlrev_b32 v138, 16, v149
    v_and_b32 v139, 0xffff0000, v149
    s_waitcnt vmcnt(8)
    v_lshlrev_b32 v140, 16, v150
    v_and_b32 v141, 0xffff0000, v150
    v_lshlrev_b32 v142, 16, v151
    v_and_b32 v143, 0xffff0000, v151
    s_waitcnt lgkmcnt(0)
    s_barrier
    ds_read_b64_tr_b16 v[160:161], v28 offset:0
    ds_read_b64_tr_b16 v[162:163], v28 offset:1024
    ds_read_b128 v[176:179], v22 offset:0
    ds_read_b128 v[180:183], v22 offset:2048
    ds_read_b128 v[184:187], v22 offset:4096
    ds_read_b128 v[188:191], v22 offset:6144
    ds_read_b64_tr_b16 v[164:165], v29 offset:0
    ds_read_b64_tr_b16 v[166:167], v29 offset:1024
    ds_read_b64_tr_b16 v[168:169], v30 offset:0
    ds_read_b64_tr_b16 v[170:171], v30 offset:1024
    ds_read_b64_tr_b16 v[172:173], v31 offset:0
    ds_read_b64_tr_b16 v[174:175], v31 offset:1024
    s_waitcnt lgkmcnt(9)
    v_mfma_f32_16x16x32_bf16 v[64:67], v[160:163], v[176:179], v[128:131]
    ds_read_b64_tr_b16 v[192:193], v28 offset:8192
    s_waitcnt lgkmcnt(9)
    v_mfma_f32_16x16x32_bf16 v[68:71], v[160:163], v[180:183], v[128:131]
    ds_read_b64_tr_b16 v[194:195], v28 offset:9216
    s_waitcnt lgkmcnt(9)
    v_mfma_f32_16x16x32_bf16 v[72:75], v[160:163], v[184:187], v[128:131]
    ds_read_b128 v[208:211], v23 offset:0
    s_waitcnt lgkmcnt(9)
    v_mfma_f32_16x16x32_bf16 v[76:79], v[160:163], v[188:191], v[128:131]
    s_waitcnt lgkmcnt(7)
    v_mfma_f32_16x16x32_bf16 v[80:83], v[164:167], v[176:179], v[132:135]
    ds_read_b128 v[212:215], v23 offset:2048
    v_mfma_f32_16x16x32_bf16 v[84:87], v[164:167], v[180:183], v[132:135]
    ds_read_b128 v[216:219], v23 offset:4096
    v_mfma_f32_16x16x32_bf16 v[88:91], v[164:167], v[184:187], v[132:135]
    ds_read_b128 v[220:223], v23 offset:6144
    v_mfma_f32_16x16x32_bf16 v[92:95], v[164:167], v[188:191], v[132:135]
    s_waitcnt lgkmcnt(8)
    v_mfma_f32_16x16x32_bf16 v[96:99], v[168:171], v[176:179], v[136:139]
    ds_read_b64_tr_b16 v[196:197], v29 offset:8192
    v_mfma_f32_16x16x32_bf16 v[100:103], v[168:171], v[180:183], v[136:139]
    ds_read_b64_tr_b16 v[198:199], v29 offset:9216
    v_mfma_f32_16x16x32_bf16 v[104:107], v[168:171], v[184:187], v[136:139]
    ds_read_b64_tr_b16 v[200:201], v30 offset:8192
    v_mfma_f32_16x16x32_bf16 v[108:111], v[168:171], v[188:191], v[136:139]
    s_waitcnt lgkmcnt(9)
    v_mfma_f32_16x16x32_bf16 v[112:115], v[172:175], v[176:179], v[140:143]
    ds_read_b64_tr_b16 v[202:203], v30 offset:9216
    v_mfma_f32_16x16x32_bf16 v[116:119], v[172:175], v[180:183], v[140:143]
    ds_read_b64_tr_b16 v[204:205], v31 offset:8192
    v_mfma_f32_16x16x32_bf16 v[120:123], v[172:175], v[184:187], v[140:143]
    ds_read_b64_tr_b16 v[206:207], v31 offset:9216
    v_mfma_f32_16x16x32_bf16 v[124:127], v[172:175], v[188:191], v[140:143]
    v_add_u32 v24, 65536, v22
    v_add_u32 v25, 65536, v23
    v_add_u32 v32, 65536, v28
    v_add_u32 v33, 65536, v29
    v_add_u32 v34, 65536, v30
    v_add_u32 v35, 65536, v31
    v_add_u32 v26, 131072, v22
    v_add_u32 v27, 131072, v23
    v_add_u32 v36, 131072, v28
    v_add_u32 v37, 131072, v29
    v_add_u32 v38, 131072, v30
    v_add_u32 v39, 131072, v31
    s_and_b32 s62, s56, 1
    s_lshr_b32 s63, s56, 1
    s_lshl1_add_u32 s62, s58, s62
    s_lshl1_add_u32 s65, s59, s63
    s_mul_i32 s64, s62, 216
    s_lshl1_add_u32 s64, s65, s64
    s_lshl_b32 s64, s64, 10
    s_lshl_b32 s62, s62, 9
    s_cmp_ge_u32 s65, 27
    s_cselect_b32 s64, 1073741824, s64
    s_cselect_b32 s62, 1073741824, s62
    v_lshl_add_u32 v40, v1, 4, s64
    v_mov_b32 v250, s62
    v_mov_b32 v42, 0xc0135761
    v_mov_b32 v44, 0xbdd2d3e8
    v_mov_b32 v46, 1.0
    v_mov_b32 v43, v42
    v_mov_b32 v45, v44
    v_mov_b32 v47, 1.0
    s_mov_b32 s34, 2211840
    s_mov_b32 s35, 0x20000
    s_mov_b32 s38, 1280
    s_mov_b32 s39, 0x20000
    s_mov_b32 s42, 2621440
    s_mov_b32 s43, 0x20000
    s_mov_b32 s46, 256
    s_mov_b32 s47, 0x20000
    s_mov_b32 s50, 7077888
    s_mov_b32 s51, 0x20000
    s_add_u32 s52, s48, 8388608
    s_addc_u32 s53, s49, 0
    s_mov_b32 s54, 16384
    s_mov_b32 s55, 0x20000
    s_lshr_b32 s63, s73, 1
    s_mul_i32 s75, s63, 28
    s_add_u32 s75, s75, s72
    s_cmp_ge_u32 s75, 110
    s_cselect_b32 s75, 125, s75
    s_mul_i32 s66, s75, 205
    s_lshr_b32 s66, s66, 10
    s_mul_i32 s62, s66, 5
    s_sub_u32 s63, s75, s62
    s_and_b32 s67, s73, 1
    s_mul_i32 s67, s67, 5
    s_add_u32 s67, s67, s63
    s_mul_i32 s63, s63, 10
    s_mul_i32 s62, s66, 10
    s_add_u32 s62, s62, s63
    s_lshr_b32 s62, s62, 2
    s_mul_i32 s63, s62, 1261
    s_lshr_b32 s63, s63, 14
    s_mul_i32 s63, s63, 13
    s_sub_u32 s62, s62, s63
    s_mul_i32 s70, s62, 163840
    s_lshl_b32 s4, s62, 12
    s_mul_i32 s62, s56, 40960
    s_lshl_b32 s63, s67, 7
    s_add_u32 s62, s62, s63
    v_lshrrev_b32 v2, 3, v1
    v_and_b32 v3, 7, v1
    v_and_b32 v4, 6, v2
    v_xor_b32 v3, v3, v4
    v_lshlrev_b32 v3, 4, v3
    v_mul_u32_u24 v4, 1280, v2
    v_add3_u32 v18, v4, v3, s62
    v_add_u32 v19, 9216, v18
    v_add_u32 v20, 18432, v18
    v_add_u32 v21, 27648, v18
    s_sub_u32 s62, s66, 16
    s_and_b32 s63, s62, 1
    s_lshr_b32 s62, s62, 1
    s_lshl2_add_u32 s62, s62, s63
    s_add_u32 s62, s62, 118
    s_add_u32 s68, s66, 100
    s_cmp_ge_u32 s66, 16
    s_cselect_b32 s68, s62, s68
    s_lshl_b32 s62, s66, 9
    s_lshr_b32 s63, s68, 2
L_hpA1:
    s_cbranch_execz L_hpA_back0
    s_lshl_b32 s63, s63, 9
    s_cmp_eq_u32 s56, 0
    s_cselect_b32 s62, s62, 1073741824
    s_cselect_b32 s63, s63, 1073741824
    v_mov_b32 v243, s62
    v_mov_b32 v249, s62
    v_writelane_b32 v249, s63, 1
    s_cmp_lt_u32 s56, 2
    s_cselect_b32 s71, 0, 1073741824
    v_lshrrev_b32 v3, 2, v1
    v_lshlrev_b32 v3, 7, v3
    v_and_b32 v4, 3, v1
    v_lshl_add_u32 v3, v4, 3, v3
    v_bfe_u32 v2, v1, 3, 2
    v_lshl_add_u32 v3, v2, 5, v3
    v_add_u32 v224, s57, v3
    v_xor_b32 v225, 32, v224
    v_xor_b32 v226, 64, v224
    v_xor_b32 v227, 96, v224
    v_add_u32 v228, 65536, v224
    v_add_u32 v229, 65536, v225
    v_add_u32 v230, 65536, v226
    v_add_u32 v231, 65536, v227
    v_add_u32 v232, 131072, v224
    v_add_u32 v233, 131072, v225
    v_add_u32 v234, 131072, v226
    v_add_u32 v235, 131072, v227
    s_lshl_b32 s62, s56, 10
    v_lshl_add_u32 v246, v1, 4, s62
    v_add_u32 v247, s71, v246
    v_and_b32 v2, 15, v1
    v_lshrrev_b32 v3, 4, v1
    s_lshl_b32 s62, s67, 7
    v_lshl_add_u32 v239, v2, 3, s62
    s_mul_i32 s63, s56, 5120
    v_mul_u32_u24 v4, 1280, v3
    v_add3_u32 v248, v4, v239, s63
    buffer_load_dwordx2 v[60:61], v239, s[36:39], 0 offen
    s_add_u32 s62, s57, 65536
    v_and_b32 v4, 7, v2
    v_xor_b32 v4, v4, v3
    v_lshlrev_b32 v4, 4, v4
    v_lshl_add_u32 v4, v2, 8, v4
    v_add_u32 v240, s62, v4
    v_xor_b32 v241, 64, v240
    s_lshl_b32 s62, s56, 2
    v_add_u32 v4, s62, v3
    v_and_b32 v5, 7, v4
    v_xor_b32 v5, v5, v2
    v_lshlrev_b32 v5, 4, v5
    v_lshl_add_u32 v5, v4, 8, v5
    v_add_u32 v242, 65536, v5
    s_add_u32 m0, s57, 65536
    s_nop 0
    buffer_load_dwordx4 v10, s[20:23], s60 offen offset:0 lds
    buffer_load_dwordx4 v11, s[20:23], s60 offen offset:1024 lds
    buffer_load_dwordx4 v12, s[20:23], s60 offen offset:2048 lds
    buffer_load_dwordx4 v13, s[20:23], s60 offen offset:3072 lds
    s_add_u32 m0, s57, 81920
    s_nop 0
    buffer_load_dwordx4 v14, s[24:27], s61 offen offset:0 lds
    s_waitcnt lgkmcnt(0)
    s_waitcnt vmcnt(6)
    s_barrier
    v_mfma_f32_16x16x32_bf16 v[64:67], v[192:195], v[208:211], v[64:67]
    ds_read_b64_tr_b16 v[160:161], v28 offset:32768
    buffer_load_dwordx4 v15, s[24:27], s61 offen offset:1024 lds
    v_mfma_f32_16x16x32_bf16 v[68:71], v[192:195], v[212:215], v[68:71]
    ds_read_b64_tr_b16 v[162:163], v28 offset:33792
    v_mfma_f32_16x16x32_bf16 v[72:75], v[192:195], v[216:219], v[72:75]
    ds_read_b128 v[176:179], v22 offset:32768
    v_mfma_f32_16x16x32_bf16 v[76:79], v[192:195], v[220:223], v[76:79]
    buffer_load_dwordx4 v16, s[24:27], s61 offen offset:2048 lds
    ds_read_b128 v[180:183], v22 offset:34816
    v_mfma_f32_16x16x32_bf16 v[80:83], v[196:199], v[208:211], v[80:83]
    ds_read_b128 v[184:187], v22 offset:36864
    v_mfma_f32_16x16x32_bf16 v[84:87], v[196:199], v[212:215], v[84:87]
    buffer_load_dwordx4 v17, s[24:27], s61 offen offset:3072 lds
    v_mfma_f32_16x16x32_bf16 v[88:91], v[196:199], v[216:219], v[88:91]
    ds_read_b128 v[188:191], v22 offset:38912
    v_mfma_f32_16x16x32_bf16 v[92:95], v[196:199], v[220:223], v[92:95]
    ds_read_b64_tr_b16 v[164:165], v29 offset:32768
    s_add_u32 s60, s60, 128
    v_mfma_f32_16x16x32_bf16 v[96:99], v[200:203], v[208:211], v[96:99]
    ds_read_b64_tr_b16 v[166:167], v29 offset:33792
    v_mfma_f32_16x16x32_bf16 v[100:103], v[200:203], v[212:215], v[100:103]
    ds_read_b64_tr_b16 v[168:169], v30 offset:32768
    v_mfma_f32_16x16x32_bf16 v[104:107], v[200:203], v[216:219], v[104:107]
    s_add_u32 s61, s61, 221184
    ds_read_b64_tr_b16 v[170:171], v30 offset:33792
    v_mfma_f32_16x16x32_bf16 v[108:111], v[200:203], v[220:223], v[108:111]
    ds_read_b64_tr_b16 v[172:173], v31 offset:32768
    v_mfma_f32_16x16x32_bf16 v[112:115], v[204:207], v[208:211], v[112:115]
    s_cmp_eq_u32 s60, 1280
    s_cselect_b32 s60, 0, s60
    s_cselect_b32 s61, 0, s61
    v_mfma_f32_16x16x32_bf16 v[116:119], v[204:207], v[212:215], v[116:119]
    ds_read_b64_tr_b16 v[174:175], v31 offset:33792
    v_mfma_f32_16x16x32_bf16 v[120:123], v[204:207], v[216:219], v[120:123]
    v_mfma_f32_16x16x32_bf16 v[124:127], v[204:207], v[220:223], v[124:127]
    s_waitcnt lgkmcnt(9)
    v_mfma_f32_16x16x32_bf16 v[64:67], v[160:163], v[176:179], v[64:67]
    ds_read_b64_tr_b16 v[192:193], v28 offset:40960
    s_add_u32 m0, s57, 98304
    s_waitcnt lgkmcnt(9)
    v_mfma_f32_16x16x32_bf16 v[68:71], v[160:163], v[180:183], v[68:71]
    s_add_u32 s5, s4, 4096
    ds_read_b64_tr_b16 v[194:195], v28 offset:41984
    s_waitcnt lgkmcnt(9)
    v_mfma_f32_16x16x32_bf16 v[72:75], v[160:163], v[184:187], v[72:75]
    ds_read_b128 v[208:211], v23 offset:32768
    buffer_load_dwordx4 v10, s[20:23], s60 offen offset:0 lds
    s_waitcnt lgkmcnt(9)
    v_mfma_f32_16x16x32_bf16 v[76:79], v[160:163], v[188:191], v[76:79]
    ds_read_b128 v[212:215], v23 offset:34816
    s_waitcnt lgkmcnt(8)
    v_mfma_f32_16x16x32_bf16 v[80:83], v[164:167], v[176:179], v[80:83]
    s_cmp_eq_u32 s5, 53248
    s_cselect_b32 s5, 0, s5
    buffer_load_dwordx4 v11, s[20:23], s60 offen offset:1024 lds
    v_mfma_f32_16x16x32_bf16 v[84:87], v[164:167], v[180:183], v[84:87]
    ds_read_b128 v[216:219], v23 offset:36864
    ds_read_b128 v[220:223], v23 offset:38912
    v_mfma_f32_16x16x32_bf16 v[88:91], v[164:167], v[184:187], v[88:91]
    buffer_load_dwordx4 v12, s[20:23], s60 offen offset:2048 lds
    v_mfma_f32_16x16x32_bf16 v[92:95], v[164:167], v[188:191], v[92:95]
    s_add_u32 s6, s5, 4096
    ds_read_b64_tr_b16 v[196:197], v29 offset:40960
    s_waitcnt lgkmcnt(9)
    v_mfma_f32_16x16x32_bf16 v[96:99], v[168:171], v[176:179], v[96:99]
    ds_read_b64_tr_b16 v[198:199], v29 offset:41984
    buffer_load_dwordx4 v13, s[20:23], s60 offen offset:3072 lds
    v_mfma_f32_16x16x32_bf16 v[100:103], v[168:171], v[180:183], v[100:103]
    s_cmp_eq_u32 s6, 53248
    s_cselect_b32 s6, 0, s6
    ds_read_b64_tr_b16 v[200:201], v30 offset:40960
    v_mfma_f32_16x16x32_bf16 v[104:107], v[168:171], v[184:187], v[104:107]
    s_add_u32 m0, s57, 114688
    v_mfma_f32_16x16x32_bf16 v[108:111], v[168:171], v[188:191], v[108:111]
    ds_read_b64_tr_b16 v[202:203], v30 offset:41984
    ds_read_b64_tr_b16 v[204:205], v31 offset:40960
    s_waitcnt lgkmcnt(11)
    v_mfma_f32_16x16x32_bf16 v[112:115], v[172:175], v[176:179], v[112:115]
    s_add_u32 s7, s6, 4096
    buffer_load_dwordx4 v14, s[24:27], s61 offen offset:0 lds
    v_mfma_f32_16x16x32_bf16 v[116:119], v[172:175], v[180:183], v[116:119]
    ds_read_b64_tr_b16 v[206:207], v31 offset:41984
    v_mfma_f32_16x16x32_bf16 v[120:123], v[172:175], v[184:187], v[120:123]
    v_mfma_f32_16x16x32_bf16 v[124:127], v[172:175], v[188:191], v[124:127]
    s_waitcnt lgkmcnt(0)
    s_waitcnt vmcnt(5)
L_pg0:
    s_cbranch_execz L_pg_back
L_hpA2:
    s_cbranch_execz L_hpA_back0
    s_barrier
    v_mfma_f32_16x16x32_bf16 v[64:67], v[192:195], v[208:211], v[64:67]
    ds_read_b64_tr_b16 v[160:161], v32 offset:0
    buffer_load_dwordx4 v15, s[24:27], s61 offen offset:1024 lds
    v_mfma_f32_16x16x32_bf16 v[68:71], v[192:195], v[212:215], v[68:71]
    s_cmp_eq_u32 s7, 53248
    s_cselect_b32 s7, 0, s7
    ds_read_b64_tr_b16 v[162:163], v32 offset:1024
    v_mfma_f32_16x16x32_bf16 v[72:75], v[192:195], v[216:219], v[72:75]
    ds_read_b128 v[176:179], v24 offset:0
    v_mfma_f32_16x16x32_bf16 v[76:79], v[192:195], v[220:223], v[76:79]
    buffer_load_dwordx4 v16, s[24:27], s61 offen offset:2048 lds
    ds_read_b128 v[180:183], v24 offset:2048
    v_mfma_f32_16x16x32_bf16 v[80:83], v[196:199], v[208:211], v[80:83]
    s_add_u32 s8, s7, 4096
    ds_read_b128 v[184:187], v24 offset:4096
    v_mfma_f32_16x16x32_bf16 v[84:87], v[196:199], v[212:215], v[84:87]
    buffer_load_dwordx4 v17, s[24:27], s61 offen offset:3072 lds
    v_mfma_f32_16x16x32_bf16 v[88:91], v[196:199], v[216:219], v[88:91]
    ds_read_b128 v[188:191], v24 offset:6144
    s_cmp_eq_u32 s8, 53248
    s_cselect_b32 s8, 0, s8
    v_mfma_f32_16x16x32_bf16 v[92:95], v[196:199], v[220:223], v[92:95]
    ds_read_b64_tr_b16 v[164:165], v33 offset:0
    s_add_u32 s60, s60, 128
    v_mfma_f32_16x16x32_bf16 v[96:99], v[200:203], v[208:211], v[96:99]
    ds_read_b64_tr_b16 v[166:167], v33 offset:1024
    v_mfma_f32_16x16x32_bf16 v[100:103], v[200:203], v[212:215], v[100:103]
    s_add_u32 s9, s8, 4096
    ds_read_b64_tr_b16 v[168:169], v34 offset:0
    v_mfma_f32_16x16x32_bf16 v[104:107], v[200:203], v[216:219], v[104:107]
    s_add_u32 s61, s61, 221184
    ds_read_b64_tr_b16 v[170:171], v34 offset:1024
    v_mfma_f32_16x16x32_bf16 v[108:111], v[200:203], v[220:223], v[108:111]
    ds_read_b64_tr_b16 v[172:173], v35 offset:0
    v_mfma_f32_16x16x32_bf16 v[112:115], v[204:207], v[208:211], v[112:115]
    s_cmp_eq_u32 s9, 53248
    s_cselect_b32 s9, 0, s9
    s_cmp_eq_u32 s60, 1280
    s_cselect_b32 s60, 0, s60
    s_cselect_b32 s61, 0, s61
    v_mfma_f32_16x16x32_bf16 v[116:119], v[204:207], v[212:215], v[116:119]
    ds_read_b64_tr_b16 v[174:175], v35 offset:1024
    v_mfma_f32_16x16x32_bf16 v[120:123], v[204:207], v[216:219], v[120:123]
    v_mfma_f32_16x16x32_bf16 v[124:127], v[204:207], v[220:223], v[124:127]
    s_waitcnt lgkmcnt(9)
    v_mfma_f32_16x16x32_bf16 v[64:67], v[160:163], v[176:179], v[64:67]
    ds_read_b64_tr_b16 v[192:193], v32 offset:8192
    s_add_u32 m0, s57, 131072
    s_waitcnt lgkmcnt(9)
    v_mfma_f32_16x16x32_bf16 v[68:71], v[160:163], v[180:183], v[68:71]
    s_add_u32 s10, s9, 4096
    ds_read_b64_tr_b16 v[194:195], v32 offset:9216
    s_waitcnt lgkmcnt(9)
    v_mfma_f32_16x16x32_bf16 v[72:75], v[160:163], v[184:187], v[72:75]
    ds_read_b128 v[208:211], v25 offset:0
    buffer_load_dwordx4 v10, s[20:23], s60 offen offset:0 lds
    s_waitcnt lgkmcnt(9)
    v_mfma_f32_16x16x32_bf16 v[76:79], v[160:163], v[188:191], v[76:79]
    ds_read_b128 v[212:215], v25 offset:2048
    s_waitcnt lgkmcnt(8)
    v_mfma_f32_16x16x32_bf16 v[80:83], v[164:167], v[176:179], v[80:83]
    s_cmp_eq_u32 s10, 53248
    s_cselect_b32 s10, 0, s10
    buffer_load_dwordx4 v11, s[20:23], s60 offen offset:1024 lds
    v_mfma_f32_16x16x32_bf16 v[84:87], v[164:167], v[180:183], v[84:87]
    ds_read_b128 v[216:219], v25 offset:4096
    ds_read_b128 v[220:223], v25 offset:6144
    v_mfma_f32_16x16x32_bf16 v[88:91], v[164:167], v[184:187], v[88:91]
    buffer_load_dwordx4 v12, s[20:23], s60 offen offset:2048 lds
    v_mfma_f32_16x16x32_bf16 v[92:95], v[164:167], v[188:191], v[92:95]
    s_add_u32 s11, s10, 4096
    ds_read_b64_tr_b16 v[196:197], v33 offset:8192
    s_waitcnt lgkmcnt(9)
    v_mfma_f32_16x16x32_bf16 v[96:99], v[168:171], v[176:179], v[96:99]
    ds_read_b64_tr_b16 v[198:199], v33 offset:9216
    buffer_load_dwordx4 v13, s[20:23], s60 offen offset:3072 lds
    v_mfma_f32_16x16x32_bf16 v[100:103], v[168:171], v[180:183], v[100:103]
    s_cmp_eq_u32 s11, 53248
    s_cselect_b32 s11, 0, s11
    ds_read_b64_tr_b16 v[200:201], v34 offset:8192
    v_mfma_f32_16x16x32_bf16 v[104:107], v[168:171], v[184:187], v[104:107]
    s_add_u32 m0, s57, 147456
    v_mfma_f32_16x16x32_bf16 v[108:111], v[168:171], v[188:191], v[108:111]
    ds_read_b64_tr_b16 v[202:203], v34 offset:9216
    ds_read_b64_tr_b16 v[204:205], v35 offset:8192
    s_waitcnt lgkmcnt(11)
    v_mfma_f32_16x16x32_bf16 v[112:115], v[172:175], v[176:179], v[112:115]
    s_add_u32 s12, s11, 4096
    buffer_load_dwordx4 v14, s[24:27], s61 offen offset:0 lds
    v_mfma_f32_16x16x32_bf16 v[116:119], v[172:175], v[180:183], v[116:119]
    ds_read_b64_tr_b16 v[206:207], v35 offset:9216
    v_mfma_f32_16x16x32_bf16 v[120:123], v[172:175], v[184:187], v[120:123]
    v_mfma_f32_16x16x32_bf16 v[124:127], v[172:175], v[188:191], v[124:127]
    s_waitcnt lgkmcnt(0)
    s_waitcnt vmcnt(5)
    s_barrier
    v_mfma_f32_16x16x32_bf16 v[64:67], v[192:195], v[208:211], v[64:67]
    ds_read_b64_tr_b16 v[160:161], v32 offset:32768
    buffer_load_dwordx4 v15, s[24:27], s61 offen offset:1024 lds
    v_mfma_f32_16x16x32_bf16 v[68:71], v[192:195], v[212:215], v[68:71]
    s_cmp_eq_u32 s12, 53248
    s_cselect_b32 s12, 0, s12
    ds_read_b64_tr_b16 v[162:163], v32 offset:33792
    v_mfma_f32_16x16x32_bf16 v[72:75], v[192:195], v[216:219], v[72:75]
    ds_read_b128 v[176:179], v24 offset:32768
    v_mfma_f32_16x16x32_bf16 v[76:79], v[192:195], v[220:223], v[76:79]
    buffer_load_dwordx4 v16, s[24:27], s61 offen offset:2048 lds
    ds_read_b128 v[180:183], v24 offset:34816
    v_mfma_f32_16x16x32_bf16 v[80:83], v[196:199], v[208:211], v[80:83]
    s_add_u32 s13, s12, 4096
    ds_read_b128 v[184:187], v24 offset:36864
    v_mfma_f32_16x16x32_bf16 v[84:87], v[196:199], v[212:215], v[84:87]
    buffer_load_dwordx4 v17, s[24:27], s61 offen offset:3072 lds
    v_mfma_f32_16x16x32_bf16 v[88:91], v[196:199], v[216:219], v[88:91]
    ds_read_b128 v[188:191], v24 offset:38912
    s_cmp_eq_u32 s13, 53248
    s_cselect_b32 s13, 0, s13
    v_mfma_f32_16x16x32_bf16 v[92:95], v[196:199], v[220:223], v[92:95]
    ds_read_b64_tr_b16 v[164:165], v33 offset:32768
    s_add_u32 s60, s60, 128
    v_mfma_f32_16x16x32_bf16 v[96:99], v[200:203], v[208:211], v[96:99]
    ds_read_b64_tr_b16 v[166:167], v33 offset:33792
    v_mfma_f32_16x16x32_bf16 v[100:103], v[200:203], v[212:215], v[100:103]
    s_add_u32 s14, s13, 4096
    ds_read_b64_tr_b16 v[168:169], v34 offset:32768
    v_mfma_f32_16x16x32_bf16 v[104:107], v[200:203], v[216:219], v[104:107]
    s_add_u32 s61, s61, 221184
    ds_read_b64_tr_b16 v[170:171], v34 offset:33792
    v_mfma_f32_16x16x32_bf16 v[108:111], v[200:203], v[220:223], v[108:111]
    ds_read_b64_tr_b16 v[172:173], v35 offset:32768
    v_mfma_f32_16x16x32_bf16 v[112:115], v[204:207], v[208:211], v[112:115]
    s_cmp_eq_u32 s14, 53248
    s_cselect_b32 s14, 0, s14
    s_cmp_eq_u32 s60, 1280
    s_cselect_b32 s60, 0, s60
    s_cselect_b32 s61, 0, s61
    v_mfma_f32_16x16x32_bf16 v[116:119], v[204:207], v[212:215], v[116:119]
    ds_read_b64_tr_b16 v[174:175], v35 offset:33792
L_hpA3:
    s_cbranch_execz L_hpA_back0
    v_mfma_f32_16x16x32_bf16 v[120:123], v[204:207], v[216:219], v[120:123]
    v_mfma_f32_16x16x32_bf16 v[124:127], v[204:207], v[220:223], v[124:127]
    s_waitcnt lgkmcnt(9)
    v_mfma_f32_16x16x32_bf16 v[64:67], v[160:163], v[176:179], v[64:67]
    ds_read_b64_tr_b16 v[192:193], v32 offset:40960
    s_add_u32 m0, s57, 0
    s_waitcnt lgkmcnt(9)
    v_mfma_f32_16x16x32_bf16 v[68:71], v[160:163], v[180:183], v[68:71]
    s_add_u32 s15, s14, 4096
    ds_read_b64_tr_b16 v[194:195], v32 offset:41984
    s_waitcnt lgkmcnt(9)
    v_mfma_f32_16x16x32_bf16 v[72:75], v[160:163], v[184:187], v[72:75]
    ds_read_b128 v[208:211], v25 offset:32768
    buffer_load_dwordx4 v10, s[20:23], s60 offen offset:0 lds
    s_waitcnt lgkmcnt(9)
    v_mfma_f32_16x16x32_bf16 v[76:79], v[160:163], v[188:191], v[76:79]
    ds_read_b128 v[212:215], v25 offset:34816
    s_waitcnt lgkmcnt(8)
    v_mfma_f32_16x16x32_bf16 v[80:83], v[164:167], v[176:179], v[80:83]
    s_cmp_eq_u32 s15, 53248
    s_cselect_b32 s15, 0, s15
    buffer_load_dwordx4 v11, s[20:23], s60 offen offset:1024 lds
    v_mfma_f32_16x16x32_bf16 v[84:87], v[164:167], v[180:183], v[84:87]
    ds_read_b128 v[216:219], v25 offset:36864
    ds_read_b128 v[220:223], v25 offset:38912
    v_mfma_f32_16x16x32_bf16 v[88:91], v[164:167], v[184:187], v[88:91]
    buffer_load_dwordx4 v12, s[20:23], s60 offen offset:2048 lds
    v_mfma_f32_16x16x32_bf16 v[92:95], v[164:167], v[188:191], v[92:95]
    s_add_u32 s16, s15, 4096
    ds_read_b64_tr_b16 v[196:197], v33 offset:40960
    s_waitcnt lgkmcnt(9)
    v_mfma_f32_16x16x32_bf16 v[96:99], v[168:171], v[176:179], v[96:99]
    ds_read_b64_tr_b16 v[198:199], v33 offset:41984
    buffer_load_dwordx4 v13, s[20:23], s60 offen offset:3072 lds
    v_mfma_f32_16x16x32_bf16 v[100:103], v[168:171], v[180:183], v[100:103]
    s_cmp_eq_u32 s16, 53248
    s_cselect_b32 s16, 0, s16
    ds_read_b64_tr_b16 v[200:201], v34 offset:40960
    v_mfma_f32_16x16x32_bf16 v[104:107], v[168:171], v[184:187], v[104:107]
    s_add_u32 m0, s57, 16384
    v_mfma_f32_16x16x32_bf16 v[108:111], v[168:171], v[188:191], v[108:111]
    ds_read_b64_tr_b16 v[202:203], v34 offset:41984
    ds_read_b64_tr_b16 v[204:205], v35 offset:40960
    s_waitcnt lgkmcnt(11)
    v_mfma_f32_16x16x32_bf16 v[112:115], v[172:175], v[176:179], v[112:115]
    s_mov_b32 s17, 53248
    buffer_load_dwordx4 v14, s[24:27], s61 offen offset:0 lds
    v_mfma_f32_16x16x32_bf16 v[116:119], v[172:175], v[180:183], v[116:119]
    ds_read_b64_tr_b16 v[206:207], v35 offset:41984
    v_mfma_f32_16x16x32_bf16 v[120:123], v[172:175], v[184:187], v[120:123]
    v_mfma_f32_16x16x32_bf16 v[124:127], v[172:175], v[188:191], v[124:127]
    s_waitcnt lgkmcnt(0)
    s_waitcnt vmcnt(5)
    s_barrier
    v_mfma_f32_16x16x32_bf16 v[64:67], v[192:195], v[208:211], v[64:67]
    ds_read_b64_tr_b16 v[160:161], v36 offset:0
    buffer_load_dwordx4 v15, s[24:27], s61 offen offset:1024 lds
    v_mfma_f32_16x16x32_bf16 v[68:71], v[192:195], v[212:215], v[68:71]
    s_lshl2_add_u32 s94, s66, 0
    ds_read_b64_tr_b16 v[162:163], v36 offset:1024
    v_mfma_f32_16x16x32_bf16 v[72:75], v[192:195], v[216:219], v[72:75]
    ds_read_b128 v[176:179], v26 offset:0
    v_mfma_f32_16x16x32_bf16 v[76:79], v[192:195], v[220:223], v[76:79]
    buffer_load_dwordx4 v16, s[24:27], s61 offen offset:2048 lds
    ds_read_b128 v[180:183], v26 offset:2048
    v_mfma_f32_16x16x32_bf16 v[80:83], v[196:199], v[208:211], v[80:83]
    s_mul_i32 s88, s94, 55296
    ds_read_b128 v[184:187], v26 offset:4096
    v_mfma_f32_16x16x32_bf16 v[84:87], v[196:199], v[212:215], v[84:87]
    buffer_load_dwordx4 v17, s[24:27], s61 offen offset:3072 lds
    v_mfma_f32_16x16x32_bf16 v[88:91], v[196:199], v[216:219], v[88:91]
    ds_read_b128 v[188:191], v26 offset:6144
    s_mul_i32 s94, s94, 20480
    v_mfma_f32_16x16x32_bf16 v[92:95], v[196:199], v[220:223], v[92:95]
    ds_read_b64_tr_b16 v[164:165], v37 offset:0
    s_add_u32 s60, s60, 128
    v_mfma_f32_16x16x32_bf16 v[96:99], v[200:203], v[208:211], v[96:99]
    ds_read_b64_tr_b16 v[166:167], v37 offset:1024
    v_mfma_f32_16x16x32_bf16 v[100:103], v[200:203], v[212:215], v[100:103]
    s_lshl2_add_u32 s95, s66, 1
    ds_read_b64_tr_b16 v[168:169], v38 offset:0
    v_mfma_f32_16x16x32_bf16 v[104:107], v[200:203], v[216:219], v[104:107]
    s_add_u32 s61, s61, 221184
    ds_read_b64_tr_b16 v[170:171], v38 offset:1024
    v_mfma_f32_16x16x32_bf16 v[108:111], v[200:203], v[220:223], v[108:111]
    ds_read_b64_tr_b16 v[172:173], v39 offset:0
    v_mfma_f32_16x16x32_bf16 v[112:115], v[204:207], v[208:211], v[112:115]
    s_mul_i32 s89, s95, 55296
    s_cmp_eq_u32 s60, 1280
    s_cselect_b32 s60, 0, s60
    s_cselect_b32 s61, 0, s61
    v_mfma_f32_16x16x32_bf16 v[116:119], v[204:207], v[212:215], v[116:119]
    ds_read_b64_tr_b16 v[174:175], v39 offset:1024
    v_mfma_f32_16x16x32_bf16 v[120:123], v[204:207], v[216:219], v[120:123]
    v_mfma_f32_16x16x32_bf16 v[124:127], v[204:207], v[220:223], v[124:127]
    s_waitcnt lgkmcnt(9)
    v_mfma_f32_16x16x32_bf16 v[64:67], v[160:163], v[176:179], v[64:67]
    ds_read_b64_tr_b16 v[192:193], v36 offset:8192
    s_add_u32 m0, s57, 32768
    s_waitcnt lgkmcnt(9)
    v_mfma_f32_16x16x32_bf16 v[68:71], v[160:163], v[180:183], v[68:71]
    s_mul_i32 s95, s95, 20480
    ds_read_b64_tr_b16 v[194:195], v36 offset:9216
    s_waitcnt lgkmcnt(9)
    v_mfma_f32_16x16x32_bf16 v[72:75], v[160:163], v[184:187], v[72:75]
    ds_read_b128 v[208:211], v27 offset:0
    buffer_load_dwordx4 v10, s[20:23], s60 offen offset:0 lds
    s_waitcnt lgkmcnt(9)
    v_mfma_f32_16x16x32_bf16 v[76:79], v[160:163], v[188:191], v[76:79]
    ds_read_b128 v[212:215], v27 offset:2048
    s_waitcnt lgkmcnt(8)
    v_mfma_f32_16x16x32_bf16 v[80:83], v[164:167], v[176:179], v[80:83]
    s_lshl2_add_u32 s96, s66, 2
    buffer_load_dwordx4 v11, s[20:23], s60 offen offset:1024 lds
    v_mfma_f32_16x16x32_bf16 v[84:87], v[164:167], v[180:183], v[84:87]
    ds_read_b128 v[216:219], v27 offset:4096
    ds_read_b128 v[220:223], v27 offset:6144
    v_mfma_f32_16x16x32_bf16 v[88:91], v[164:167], v[184:187], v[88:91]
    buffer_load_dwordx4 v12, s[20:23], s60 offen offset:2048 lds
    v_mfma_f32_16x16x32_bf16 v[92:95], v[164:167], v[188:191], v[92:95]
    s_mul_i32 s90, s96, 55296
    ds_read_b64_tr_b16 v[196:197], v37 offset:8192
    s_waitcnt lgkmcnt(9)
    v_mfma_f32_16x16x32_bf16 v[96:99], v[168:171], v[176:179], v[96:99]
    ds_read_b64_tr_b16 v[198:199], v37 offset:9216
    buffer_load_dwordx4 v13, s[20:23], s60 offen offset:3072 lds
    v_mfma_f32_16x16x32_bf16 v[100:103], v[168:171], v[180:183], v[100:103]
    s_mul_i32 s96, s96, 20480
    ds_read_b64_tr_b16 v[200:201], v38 offset:8192
    v_mfma_f32_16x16x32_bf16 v[104:107], v[168:171], v[184:187], v[104:107]
    s_add_u32 m0, s57, 49152
    v_mfma_f32_16x16x32_bf16 v[108:111], v[168:171], v[188:191], v[108:111]
    ds_read_b64_tr_b16 v[202:203], v38 offset:9216
    ds_read_b64_tr_b16 v[204:205], v39 offset:8192
    s_waitcnt lgkmcnt(11)
    v_mfma_f32_16x16x32_bf16 v[112:115], v[172:175], v[176:179], v[112:115]
    s_lshl2_add_u32 s97, s66, 3
    buffer_load_dwordx4 v14, s[24:27], s61 offen offset:0 lds
    v_mfma_f32_16x16x32_bf16 v[116:119], v[172:175], v[180:183], v[116:119]
    ds_read_b64_tr_b16 v[206:207], v39 offset:9216
L_hpA4:
    s_cbranch_execz L_hpA_back0
    v_mfma_f32_16x16x32_bf16 v[120:123], v[172:175], v[184:187], v[120:123]
    v_mfma_f32_16x16x32_bf16 v[124:127], v[172:175], v[188:191], v[124:127]
    s_waitcnt lgkmcnt(0)
    s_waitcnt vmcnt(5)
    s_barrier
    v_mfma_f32_16x16x32_bf16 v[64:67], v[192:195], v[208:211], v[64:67]
    ds_read_b64_tr_b16 v[160:161], v28 offset:0
    buffer_load_dwordx4 v15, s[24:27], s61 offen offset:1024 lds
    v_mfma_f32_16x16x32_bf16 v[68:71], v[192:195], v[212:215], v[68:71]
    s_mul_i32 s91, s97, 55296
    ds_read_b64_tr_b16 v[162:163], v28 offset:1024
    v_mfma_f32_16x16x32_bf16 v[72:75], v[192:195], v[216:219], v[72:75]
    ds_read_b128 v[176:179], v22 offset:0
    v_mfma_f32_16x16x32_bf16 v[76:79], v[192:195], v[220:223], v[76:79]
    buffer_load_dwordx4 v16, s[24:27], s61 offen offset:2048 lds
    ds_read_b128 v[180:183], v22 offset:2048
    v_mfma_f32_16x16x32_bf16 v[80:83], v[196:199], v[208:211], v[80:83]
    s_mul_i32 s97, s97, 20480
    ds_read_b128 v[184:187], v22 offset:4096
    v_mfma_f32_16x16x32_bf16 v[84:87], v[196:199], v[212:215], v[84:87]
    buffer_load_dwordx4 v17, s[24:27], s61 offen offset:3072 lds
    v_mfma_f32_16x16x32_bf16 v[88:91], v[196:199], v[216:219], v[88:91]
    ds_read_b128 v[188:191], v22 offset:6144
    s_add_u32 s98, s68, 0
    v_mfma_f32_16x16x32_bf16 v[92:95], v[196:199], v[220:223], v[92:95]
    ds_read_b64_tr_b16 v[164:165], v29 offset:0
    s_add_u32 s60, s60, 128
    v_mfma_f32_16x16x32_bf16 v[96:99], v[200:203], v[208:211], v[96:99]
    ds_read_b64_tr_b16 v[166:167], v29 offset:1024
    v_mfma_f32_16x16x32_bf16 v[100:103], v[200:203], v[212:215], v[100:103]
    s_mul_i32 s92, s98, 55296
    ds_read_b64_tr_b16 v[168:169], v30 offset:0
    v_mfma_f32_16x16x32_bf16 v[104:107], v[200:203], v[216:219], v[104:107]
    s_add_u32 s61, s61, 221184
    ds_read_b64_tr_b16 v[170:171], v30 offset:1024
    v_mfma_f32_16x16x32_bf16 v[108:111], v[200:203], v[220:223], v[108:111]
    ds_read_b64_tr_b16 v[172:173], v31 offset:0
    v_mfma_f32_16x16x32_bf16 v[112:115], v[204:207], v[208:211], v[112:115]
    s_mul_i32 s98, s98, 20480
    s_cmp_eq_u32 s60, 1280
    s_cselect_b32 s60, 0, s60
    s_cselect_b32 s61, 0, s61
    v_mfma_f32_16x16x32_bf16 v[116:119], v[204:207], v[212:215], v[116:119]
    ds_read_b64_tr_b16 v[174:175], v31 offset:1024
    v_mfma_f32_16x16x32_bf16 v[120:123], v[204:207], v[216:219], v[120:123]
    v_mfma_f32_16x16x32_bf16 v[124:127], v[204:207], v[220:223], v[124:127]
    s_waitcnt lgkmcnt(9)
    v_mfma_f32_16x16x32_bf16 v[64:67], v[160:163], v[176:179], v[64:67]
    ds_read_b64_tr_b16 v[192:193], v28 offset:8192
    s_add_u32 m0, s57, 65536
    s_waitcnt lgkmcnt(9)
    v_mfma_f32_16x16x32_bf16 v[68:71], v[160:163], v[180:183], v[68:71]
    ds_read_b64_tr_b16 v[194:195], v28 offset:9216
    s_mov_b32 s76, 55296
    s_waitcnt lgkmcnt(9)
    v_mfma_f32_16x16x32_bf16 v[72:75], v[160:163], v[184:187], v[72:75]
    ds_read_b128 v[208:211], v23 offset:0
    s_waitcnt lgkmcnt(9)
    v_mfma_f32_16x16x32_bf16 v[76:79], v[160:163], v[188:191], v[76:79]
    buffer_load_dwordx4 v10, s[20:23], s60 offen offset:0 lds
    ds_read_b128 v[212:215], v23 offset:2048
    s_waitcnt lgkmcnt(8)
    v_mfma_f32_16x16x32_bf16 v[80:83], v[164:167], v[176:179], v[80:83]
    buffer_load_dwordx4 v11, s[20:23], s60 offen offset:1024 lds
    v_mfma_f32_16x16x32_bf16 v[84:87], v[164:167], v[180:183], v[84:87]
    ds_read_b128 v[216:219], v23 offset:4096
    ds_read_b128 v[220:223], v23 offset:6144
    v_mfma_f32_16x16x32_bf16 v[88:91], v[164:167], v[184:187], v[88:91]
    buffer_load_dwordx4 v12, s[20:23], s60 offen offset:2048 lds
    v_mfma_f32_16x16x32_bf16 v[92:95], v[164:167], v[188:191], v[92:95]
    s_mov_b32 s77, 110592
    ds_read_b64_tr_b16 v[196:197], v29 offset:8192
    s_waitcnt lgkmcnt(9)
    v_mfma_f32_16x16x32_bf16 v[96:99], v[168:171], v[176:179], v[96:99]
    ds_read_b64_tr_b16 v[198:199], v29 offset:9216
    buffer_load_dwordx4 v13, s[20:23], s60 offen offset:3072 lds
    v_mfma_f32_16x16x32_bf16 v[100:103], v[168:171], v[180:183], v[100:103]
    ds_read_b64_tr_b16 v[200:201], v30 offset:8192
    v_mfma_f32_16x16x32_bf16 v[104:107], v[168:171], v[184:187], v[104:107]
    s_add_u32 m0, s57, 81920
    ds_read_b64_tr_b16 v[202:203], v30 offset:9216
    v_mfma_f32_16x16x32_bf16 v[108:111], v[168:171], v[188:191], v[108:111]
    s_mov_b32 s78, 165888
    s_waitcnt lgkmcnt(10)
    v_mfma_f32_16x16x32_bf16 v[112:115], v[172:175], v[176:179], v[112:115]
    ds_read_b64_tr_b16 v[204:205], v31 offset:8192
    buffer_load_dwordx4 v14, s[24:27], s61 offen offset:0 lds
    v_mfma_f32_16x16x32_bf16 v[116:119], v[172:175], v[180:183], v[116:119]
    ds_read_b64_tr_b16 v[206:207], v31 offset:9216
    v_mfma_f32_16x16x32_bf16 v[120:123], v[172:175], v[184:187], v[120:123]
    v_mfma_f32_16x16x32_bf16 v[124:127], v[172:175], v[188:191], v[124:127]
    s_waitcnt lgkmcnt(0)
    s_waitcnt vmcnt(5)
    s_barrier
    v_mfma_f32_16x16x32_bf16 v[64:67], v[192:195], v[208:211], v[64:67]
    ds_read_b64_tr_b16 v[160:161], v28 offset:32768
    buffer_load_dwordx4 v15, s[24:27], s61 offen offset:1024 lds
    v_mfma_f32_16x16x32_bf16 v[68:71], v[192:195], v[212:215], v[68:71]
    ds_read_b64_tr_b16 v[162:163], v28 offset:33792
    v_mfma_f32_16x16x32_bf16 v[72:75], v[192:195], v[216:219], v[72:75]
    ds_read_b128 v[176:179], v22 offset:32768
    v_mfma_f32_16x16x32_bf16 v[76:79], v[192:195], v[220:223], v[76:79]
    buffer_load_dwordx4 v16, s[24:27], s61 offen offset:2048 lds
    ds_read_b128 v[180:183], v22 offset:34816
    v_mfma_f32_16x16x32_bf16 v[80:83], v[196:199], v[208:211], v[80:83]
    ds_read_b128 v[184:187], v22 offset:36864
    v_mfma_f32_16x16x32_bf16 v[84:87], v[196:199], v[212:215], v[84:87]
    buffer_load_dwordx4 v17, s[24:27], s61 offen offset:3072 lds
    v_mfma_f32_16x16x32_bf16 v[88:91], v[196:199], v[216:219], v[88:91]
    ds_read_b128 v[188:191], v22 offset:38912
    v_mfma_f32_16x16x32_bf16 v[92:95], v[196:199], v[220:223], v[92:95]
    ds_read_b64_tr_b16 v[164:165], v29 offset:32768
    s_add_u32 s60, s60, 128
    v_mfma_f32_16x16x32_bf16 v[96:99], v[200:203], v[208:211], v[96:99]
    ds_read_b64_tr_b16 v[166:167], v29 offset:33792
    v_mfma_f32_16x16x32_bf16 v[100:103], v[200:203], v[212:215], v[100:103]
    ds_read_b64_tr_b16 v[168:169], v30 offset:32768
    v_mfma_f32_16x16x32_bf16 v[104:107], v[200:203], v[216:219], v[104:107]
    s_add_u32 s61, s61, 221184
    ds_read_b64_tr_b16 v[170:171], v30 offset:33792
    v_mfma_f32_16x16x32_bf16 v[108:111], v[200:203], v[220:223], v[108:111]
    ds_read_b64_tr_b16 v[172:173], v31 offset:32768
    v_mfma_f32_16x16x32_bf16 v[112:115], v[204:207], v[208:211], v[112:115]
    s_cmp_eq_u32 s60, 1280
    s_cselect_b32 s60, 0, s60
    s_cselect_b32 s61, 0, s61
    v_mfma_f32_16x16x32_bf16 v[116:119], v[204:207], v[212:215], v[116:119]
    ds_read_b64_tr_b16 v[174:175], v31 offset:33792
    v_mfma_f32_16x16x32_bf16 v[120:123], v[204:207], v[216:219], v[120:123]
    v_mfma_f32_16x16x32_bf16 v[124:127], v[204:207], v[220:223], v[124:127]
    s_waitcnt lgkmcnt(9)
    v_mfma_f32_16x16x32_bf16 v[64:67], v[160:163], v[176:179], v[64:67]
    ds_read_b64_tr_b16 v[192:193], v28 offset:40960
    s_add_u32 m0, s57, 98304
    s_waitcnt lgkmcnt(9)
    v_mfma_f32_16x16x32_bf16 v[68:71], v[160:163], v[180:183], v[68:71]
    ds_read_b64_tr_b16 v[194:195], v28 offset:41984
    s_waitcnt lgkmcnt(9)
L_hpA5:
    s_cbranch_execz L_hpA_back0
    v_mfma_f32_16x16x32_bf16 v[72:75], v[160:163], v[184:187], v[72:75]
    ds_read_b128 v[208:211], v23 offset:32768
    buffer_load_dwordx4 v10, s[20:23], s60 offen offset:0 lds
    s_waitcnt lgkmcnt(9)
    v_mfma_f32_16x16x32_bf16 v[76:79], v[160:163], v[188:191], v[76:79]
    ds_read_b128 v[212:215], v23 offset:34816
    s_waitcnt lgkmcnt(8)
    v_mfma_f32_16x16x32_bf16 v[80:83], v[164:167], v[176:179], v[80:83]
    buffer_load_dwordx4 v11, s[20:23], s60 offen offset:1024 lds
    v_mfma_f32_16x16x32_bf16 v[84:87], v[164:167], v[180:183], v[84:87]
    ds_read_b128 v[216:219], v23 offset:36864
    ds_read_b128 v[220:223], v23 offset:38912
    v_mfma_f32_16x16x32_bf16 v[88:91], v[164:167], v[184:187], v[88:91]
    buffer_load_dwordx4 v12, s[20:23], s60 offen offset:2048 lds
    v_mfma_f32_16x16x32_bf16 v[92:95], v[164:167], v[188:191], v[92:95]
    ds_read_b64_tr_b16 v[196:197], v29 offset:40960
    s_waitcnt lgkmcnt(9)
    v_mfma_f32_16x16x32_bf16 v[96:99], v[168:171], v[176:179], v[96:99]
    ds_read_b64_tr_b16 v[198:199], v29 offset:41984
    buffer_load_dwordx4 v13, s[20:23], s60 offen offset:3072 lds
    v_mfma_f32_16x16x32_bf16 v[100:103], v[168:171], v[180:183], v[100:103]
    ds_read_b64_tr_b16 v[200:201], v30 offset:40960
    v_mfma_f32_16x16x32_bf16 v[104:107], v[168:171], v[184:187], v[104:107]
    s_add_u32 m0, s57, 114688
    v_mfma_f32_16x16x32_bf16 v[108:111], v[168:171], v[188:191], v[108:111]
    ds_read_b64_tr_b16 v[202:203], v30 offset:41984
    ds_read_b64_tr_b16 v[204:205], v31 offset:40960
    s_waitcnt lgkmcnt(11)
    v_mfma_f32_16x16x32_bf16 v[112:115], v[172:175], v[176:179], v[112:115]
    buffer_load_dwordx4 v14, s[24:27], s61 offen offset:0 lds
    v_mfma_f32_16x16x32_bf16 v[116:119], v[172:175], v[180:183], v[116:119]
    ds_read_b64_tr_b16 v[206:207], v31 offset:41984
    v_mfma_f32_16x16x32_bf16 v[120:123], v[172:175], v[184:187], v[120:123]
    v_mfma_f32_16x16x32_bf16 v[124:127], v[172:175], v[188:191], v[124:127]
    s_waitcnt lgkmcnt(0)
    s_waitcnt vmcnt(5)
    s_barrier
    v_mfma_f32_16x16x32_bf16 v[64:67], v[192:195], v[208:211], v[64:67]
    ds_read_b64_tr_b16 v[160:161], v32 offset:0
    buffer_load_dwordx4 v15, s[24:27], s61 offen offset:1024 lds
    v_mfma_f32_16x16x32_bf16 v[68:71], v[192:195], v[212:215], v[68:71]
    ds_read_b64_tr_b16 v[162:163], v32 offset:1024
    v_mfma_f32_16x16x32_bf16 v[72:75], v[192:195], v[216:219], v[72:75]
    ds_read_b128 v[176:179], v24 offset:0
    v_mfma_f32_16x16x32_bf16 v[76:79], v[192:195], v[220:223], v[76:79]
    buffer_load_dwordx4 v16, s[24:27], s61 offen offset:2048 lds
    ds_read_b128 v[180:183], v24 offset:2048
    v_mfma_f32_16x16x32_bf16 v[80:83], v[196:199], v[208:211], v[80:83]
    ds_read_b128 v[184:187], v24 offset:4096
    v_mfma_f32_16x16x32_bf16 v[84:87], v[196:199], v[212:215], v[84:87]
    buffer_load_dwordx4 v17, s[24:27], s61 offen offset:3072 lds
    v_mfma_f32_16x16x32_bf16 v[88:91], v[196:199], v[216:219], v[88:91]
    ds_read_b128 v[188:191], v24 offset:6144
    v_mfma_f32_16x16x32_bf16 v[92:95], v[196:199], v[220:223], v[92:95]
    ds_read_b64_tr_b16 v[164:165], v33 offset:0
    s_add_u32 s60, s60, 128
    v_mfma_f32_16x16x32_bf16 v[96:99], v[200:203], v[208:211], v[96:99]
    ds_read_b64_tr_b16 v[166:167], v33 offset:1024
    v_mfma_f32_16x16x32_bf16 v[100:103], v[200:203], v[212:215], v[100:103]
    ds_read_b64_tr_b16 v[168:169], v34 offset:0
    v_mfma_f32_16x16x32_bf16 v[104:107], v[200:203], v[216:219], v[104:107]
    s_add_u32 s61, s61, 221184
    ds_read_b64_tr_b16 v[170:171], v34 offset:1024
    v_mfma_f32_16x16x32_bf16 v[108:111], v[200:203], v[220:223], v[108:111]
    ds_read_b64_tr_b16 v[172:173], v35 offset:0
    v_mfma_f32_16x16x32_bf16 v[112:115], v[204:207], v[208:211], v[112:115]
    s_cmp_eq_u32 s60, 1280
    s_cselect_b32 s60, 0, s60
    s_cselect_b32 s61, 0, s61
    v_mfma_f32_16x16x32_bf16 v[116:119], v[204:207], v[212:215], v[116:119]
    ds_read_b64_tr_b16 v[174:175], v35 offset:1024
    v_mfma_f32_16x16x32_bf16 v[120:123], v[204:207], v[216:219], v[120:123]
    v_mfma_f32_16x16x32_bf16 v[124:127], v[204:207], v[220:223], v[124:127]
    s_waitcnt lgkmcnt(9)
    v_mfma_f32_16x16x32_bf16 v[64:67], v[160:163], v[176:179], v[64:67]
    ds_read_b64_tr_b16 v[192:193], v32 offset:8192
    s_add_u32 m0, s57, 131072
    s_waitcnt lgkmcnt(9)
    v_mfma_f32_16x16x32_bf16 v[68:71], v[160:163], v[180:183], v[68:71]
    ds_read_b64_tr_b16 v[194:195], v32 offset:9216
    s_waitcnt lgkmcnt(9)
    v_mfma_f32_16x16x32_bf16 v[72:75], v[160:163], v[184:187], v[72:75]
    ds_read_b128 v[208:211], v25 offset:0
    s_waitcnt lgkmcnt(9)
    v_mfma_f32_16x16x32_bf16 v[76:79], v[160:163], v[188:191], v[76:79]
    ds_read_b128 v[212:215], v25 offset:2048
    s_waitcnt lgkmcnt(8)
    v_mfma_f32_16x16x32_bf16 v[80:83], v[164:167], v[176:179], v[80:83]
    buffer_load_dwordx4 v10, s[20:23], s60 offen offset:0 lds
    ds_read_b128 v[216:219], v25 offset:4096
    v_mfma_f32_16x16x32_bf16 v[84:87], v[164:167], v[180:183], v[84:87]
    ds_read_b128 v[220:223], v25 offset:6144
    v_mfma_f32_16x16x32_bf16 v[88:91], v[164:167], v[184:187], v[88:91]
    buffer_load_dwordx4 v11, s[20:23], s60 offen offset:1024 lds
    v_mfma_f32_16x16x32_bf16 v[92:95], v[164:167], v[188:191], v[92:95]
    ds_read_b64_tr_b16 v[196:197], v33 offset:8192
    s_waitcnt lgkmcnt(9)
    v_mfma_f32_16x16x32_bf16 v[96:99], v[168:171], v[176:179], v[96:99]
    ds_read_b64_tr_b16 v[198:199], v33 offset:9216
    v_mfma_f32_16x16x32_bf16 v[100:103], v[168:171], v[180:183], v[100:103]
    buffer_load_dwordx4 v12, s[20:23], s60 offen offset:2048 lds
    ds_read_b64_tr_b16 v[200:201], v34 offset:8192
    v_mfma_f32_16x16x32_bf16 v[104:107], v[168:171], v[184:187], v[104:107]
    ds_read_b64_tr_b16 v[202:203], v34 offset:9216
    v_mfma_f32_16x16x32_bf16 v[108:111], v[168:171], v[188:191], v[108:111]
    ds_read_b64_tr_b16 v[204:205], v35 offset:8192
    s_waitcnt lgkmcnt(11)
    v_mfma_f32_16x16x32_bf16 v[112:115], v[172:175], v[176:179], v[112:115]
    buffer_load_dwordx4 v13, s[20:23], s60 offen offset:3072 lds
    v_mfma_f32_16x16x32_bf16 v[116:119], v[172:175], v[180:183], v[116:119]
    ds_read_b64_tr_b16 v[206:207], v35 offset:9216
    v_mfma_f32_16x16x32_bf16 v[120:123], v[172:175], v[184:187], v[120:123]
    v_mfma_f32_16x16x32_bf16 v[124:127], v[172:175], v[188:191], v[124:127]
    s_waitcnt lgkmcnt(0)
    s_waitcnt vmcnt(4)
    s_barrier
    v_mfma_f32_16x16x32_bf16 v[64:67], v[192:195], v[208:211], v[64:67]
    ds_read_b64_tr_b16 v[160:161], v32 offset:32768
    s_add_u32 m0, s57, 147456
    v_mfma_f32_16x16x32_bf16 v[68:71], v[192:195], v[212:215], v[68:71]
    ds_read_b64_tr_b16 v[162:163], v32 offset:33792
    v_mfma_f32_16x16x32_bf16 v[72:75], v[192:195], v[216:219], v[72:75]
    ds_read_b128 v[176:179], v24 offset:32768
    v_mfma_f32_16x16x32_bf16 v[76:79], v[192:195], v[220:223], v[76:79]
    ds_read_b128 v[180:183], v24 offset:34816
    v_mfma_f32_16x16x32_bf16 v[80:83], v[196:199], v[208:211], v[80:83]
    buffer_load_dwordx4 v14, s[24:27], s61 offen offset:0 lds
    ds_read_b128 v[184:187], v24 offset:36864
    v_mfma_f32_16x16x32_bf16 v[84:87], v[196:199], v[212:215], v[84:87]
    ds_read_b128 v[188:191], v24 offset:38912
    v_mfma_f32_16x16x32_bf16 v[88:91], v[196:199], v[216:219], v[88:91]
    buffer_load_dwordx4 v15, s[24:27], s61 offen offset:1024 lds
    v_mfma_f32_16x16x32_bf16 v[92:95], v[196:199], v[220:223], v[92:95]
    ds_read_b64_tr_b16 v[164:165], v33 offset:32768
    v_mfma_f32_16x16x32_bf16 v[96:99], v[200:203], v[208:211], v[96:99]
    ds_read_b64_tr_b16 v[166:167], v33 offset:33792
    v_mfma_f32_16x16x32_bf16 v[100:103], v[200:203], v[212:215], v[100:103]
L_pg1:
    s_cbranch_execz L_pg_back
L_hpA6:
    s_cbranch_execz L_hpA_back0
    buffer_load_dwordx4 v16, s[24:27], s61 offen offset:2048 lds
    ds_read_b64_tr_b16 v[168:169], v34 offset:32768
    v_mfma_f32_16x16x32_bf16 v[104:107], v[200:203], v[216:219], v[104:107]
    ds_read_b64_tr_b16 v[170:171], v34 offset:33792
    v_mfma_f32_16x16x32_bf16 v[108:111], v[200:203], v[220:223], v[108:111]
    ds_read_b64_tr_b16 v[172:173], v35 offset:32768
    v_mfma_f32_16x16x32_bf16 v[112:115], v[204:207], v[208:211], v[112:115]
    buffer_load_dwordx4 v17, s[24:27], s61 offen offset:3072 lds
    v_mfma_f32_16x16x32_bf16 v[116:119], v[204:207], v[212:215], v[116:119]
    ds_read_b64_tr_b16 v[174:175], v35 offset:33792
    v_mfma_f32_16x16x32_bf16 v[120:123], v[204:207], v[216:219], v[120:123]
    v_mfma_f32_16x16x32_bf16 v[124:127], v[204:207], v[220:223], v[124:127]
    s_waitcnt lgkmcnt(9)
    v_mfma_f32_16x16x32_bf16 v[64:67], v[160:163], v[176:179], v[64:67]
    ds_read_b64_tr_b16 v[192:193], v32 offset:40960
    s_add_u32 m0, s57, 0
    s_waitcnt lgkmcnt(9)
    v_mfma_f32_16x16x32_bf16 v[68:71], v[160:163], v[180:183], v[68:71]
    ds_read_b64_tr_b16 v[194:195], v32 offset:41984
    s_waitcnt lgkmcnt(9)
    v_mfma_f32_16x16x32_bf16 v[72:75], v[160:163], v[184:187], v[72:75]
    ds_read_b128 v[208:211], v25 offset:32768
    buffer_load_dwordx4 v18, s[32:35], s70 offen offset:0 lds
    s_waitcnt lgkmcnt(9)
    v_mfma_f32_16x16x32_bf16 v[76:79], v[160:163], v[188:191], v[76:79]
    ds_read_b128 v[212:215], v25 offset:34816
    s_waitcnt lgkmcnt(8)
    v_mfma_f32_16x16x32_bf16 v[80:83], v[164:167], v[176:179], v[80:83]
    buffer_load_dwordx4 v19, s[32:35], s70 offen offset:1024 lds
    ds_read_b128 v[216:219], v25 offset:36864
    v_mfma_f32_16x16x32_bf16 v[84:87], v[164:167], v[180:183], v[84:87]
    ds_read_b128 v[220:223], v25 offset:38912
    v_mfma_f32_16x16x32_bf16 v[88:91], v[164:167], v[184:187], v[88:91]
    buffer_load_dwordx4 v20, s[32:35], s70 offen offset:2048 lds
    v_mfma_f32_16x16x32_bf16 v[92:95], v[164:167], v[188:191], v[92:95]
    v_mov_b32 v2, 0
    buffer_load_dword v244, v2, s[44:47], 0 offen sc1
    ds_read_b64_tr_b16 v[196:197], v33 offset:40960
    s_waitcnt lgkmcnt(9)
    v_mfma_f32_16x16x32_bf16 v[96:99], v[168:171], v[176:179], v[96:99]
    ds_read_b64_tr_b16 v[198:199], v33 offset:41984
    v_mfma_f32_16x16x32_bf16 v[100:103], v[168:171], v[180:183], v[100:103]
    buffer_load_dwordx4 v21, s[32:35], s70 offen offset:3072 lds
    ds_read_b64_tr_b16 v[200:201], v34 offset:40960
    v_mfma_f32_16x16x32_bf16 v[104:107], v[168:171], v[184:187], v[104:107]
    s_add_u32 s70, s70, 163840
    v_mfma_f32_16x16x32_bf16 v[108:111], v[168:171], v[188:191], v[108:111]
    ds_read_b64_tr_b16 v[202:203], v34 offset:41984
    ds_read_b64_tr_b16 v[204:205], v35 offset:40960
    s_waitcnt lgkmcnt(11)
    v_mfma_f32_16x16x32_bf16 v[112:115], v[172:175], v[176:179], v[112:115]
    s_cmp_eq_u32 s70, 2129920
    s_cselect_b32 s70, 0, s70
    v_mfma_f32_16x16x32_bf16 v[116:119], v[172:175], v[180:183], v[116:119]
    ds_read_b64_tr_b16 v[206:207], v35 offset:41984
    v_mfma_f32_16x16x32_bf16 v[120:123], v[172:175], v[184:187], v[120:123]
    v_mfma_f32_16x16x32_bf16 v[124:127], v[172:175], v[188:191], v[124:127]
    s_waitcnt lgkmcnt(0)
    s_waitcnt vmcnt(5)
    s_barrier
    v_mfma_f32_16x16x32_bf16 v[64:67], v[192:195], v[208:211], v[64:67]
    ds_read_b64_tr_b16 v[160:161], v36 offset:0
    s_add_u32 m0, s57, 16384
    v_mfma_f32_16x16x32_bf16 v[68:71], v[192:195], v[212:215], v[68:71]
    ds_read_b64_tr_b16 v[162:163], v36 offset:1024
    v_mfma_f32_16x16x32_bf16 v[72:75], v[192:195], v[216:219], v[72:75]
    ds_read_b128 v[176:179], v26 offset:0
    buffer_load_dwordx4 v18, s[32:35], s70 offen offset:0 lds
    v_mfma_f32_16x16x32_bf16 v[76:79], v[192:195], v[220:223], v[76:79]
    ds_read_b128 v[180:183], v26 offset:2048
    v_mfma_f32_16x16x32_bf16 v[80:83], v[196:199], v[208:211], v[80:83]
    buffer_load_dwordx4 v19, s[32:35], s70 offen offset:1024 lds
    v_mfma_f32_16x16x32_bf16 v[84:87], v[196:199], v[212:215], v[84:87]
    ds_read_b128 v[184:187], v26 offset:4096
    ds_read_b128 v[188:191], v26 offset:6144
    v_mfma_f32_16x16x32_bf16 v[88:91], v[196:199], v[216:219], v[88:91]
    buffer_load_dwordx4 v20, s[32:35], s70 offen offset:2048 lds
    v_mfma_f32_16x16x32_bf16 v[92:95], v[196:199], v[220:223], v[92:95]
    ds_read_b64_tr_b16 v[164:165], v37 offset:0
    v_mfma_f32_16x16x32_bf16 v[96:99], v[200:203], v[208:211], v[96:99]
    ds_read_b64_tr_b16 v[166:167], v37 offset:1024
    buffer_load_dwordx4 v21, s[32:35], s70 offen offset:3072 lds
    v_mfma_f32_16x16x32_bf16 v[100:103], v[200:203], v[212:215], v[100:103]
    ds_read_b64_tr_b16 v[168:169], v38 offset:0
    v_mfma_f32_16x16x32_bf16 v[104:107], v[200:203], v[216:219], v[104:107]
    s_add_u32 s70, s70, 163840
    v_mfma_f32_16x16x32_bf16 v[108:111], v[200:203], v[220:223], v[108:111]
    ds_read_b64_tr_b16 v[170:171], v38 offset:1024
    ds_read_b64_tr_b16 v[172:173], v39 offset:0
    v_mfma_f32_16x16x32_bf16 v[112:115], v[204:207], v[208:211], v[112:115]
    s_cmp_eq_u32 s70, 2129920
    s_cselect_b32 s70, 0, s70
    v_mfma_f32_16x16x32_bf16 v[116:119], v[204:207], v[212:215], v[116:119]
    ds_read_b64_tr_b16 v[174:175], v39 offset:1024
    v_mfma_f32_16x16x32_bf16 v[120:123], v[204:207], v[216:219], v[120:123]
    v_mfma_f32_16x16x32_bf16 v[124:127], v[204:207], v[220:223], v[124:127]
    s_waitcnt lgkmcnt(9)
    v_mfma_f32_16x16x32_bf16 v[64:67], v[160:163], v[176:179], v[64:67]
    ds_read_b64_tr_b16 v[192:193], v36 offset:8192
    s_add_u32 m0, s57, 32768
    s_waitcnt lgkmcnt(9)
    v_mfma_f32_16x16x32_bf16 v[68:71], v[160:163], v[180:183], v[68:71]
    ds_read_b64_tr_b16 v[194:195], v36 offset:9216
    s_waitcnt lgkmcnt(9)
    v_mfma_f32_16x16x32_bf16 v[72:75], v[160:163], v[184:187], v[72:75]
    ds_read_b128 v[208:211], v27 offset:0
    buffer_load_dwordx4 v18, s[32:35], s70 offen offset:0 lds
    s_waitcnt lgkmcnt(9)
    v_mfma_f32_16x16x32_bf16 v[76:79], v[160:163], v[188:191], v[76:79]
    ds_read_b128 v[212:215], v27 offset:2048
    s_waitcnt lgkmcnt(8)
    v_mfma_f32_16x16x32_bf16 v[80:83], v[164:167], v[176:179], v[80:83]
    buffer_load_dwordx4 v19, s[32:35], s70 offen offset:1024 lds
    v_mfma_f32_16x16x32_bf16 v[84:87], v[164:167], v[180:183], v[84:87]
    ds_read_b128 v[216:219], v27 offset:4096
    ds_read_b128 v[220:223], v27 offset:6144
    v_mfma_f32_16x16x32_bf16 v[88:91], v[164:167], v[184:187], v[88:91]
    buffer_load_dwordx4 v20, s[32:35], s70 offen offset:2048 lds
    v_mfma_f32_16x16x32_bf16 v[92:95], v[164:167], v[188:191], v[92:95]
    ds_read_b64_tr_b16 v[196:197], v37 offset:8192
    s_waitcnt lgkmcnt(9)
    v_mfma_f32_16x16x32_bf16 v[96:99], v[168:171], v[176:179], v[96:99]
    ds_read_b64_tr_b16 v[198:199], v37 offset:9216
    buffer_load_dwordx4 v21, s[32:35], s70 offen offset:3072 lds
    v_mfma_f32_16x16x32_bf16 v[100:103], v[168:171], v[180:183], v[100:103]
    ds_read_b64_tr_b16 v[200:201], v38 offset:8192
    v_mfma_f32_16x16x32_bf16 v[104:107], v[168:171], v[184:187], v[104:107]
    s_add_u32 s70, s70, 163840
    v_mfma_f32_16x16x32_bf16 v[108:111], v[168:171], v[188:191], v[108:111]
    ds_read_b64_tr_b16 v[202:203], v38 offset:9216
    ds_read_b64_tr_b16 v[204:205], v39 offset:8192
    s_waitcnt lgkmcnt(11)
    v_mfma_f32_16x16x32_bf16 v[112:115], v[172:175], v[176:179], v[112:115]
    s_cmp_eq_u32 s70, 2129920
    s_cselect_b32 s70, 0, s70
    v_mfma_f32_16x16x32_bf16 v[116:119], v[172:175], v[180:183], v[116:119]
    ds_read_b64_tr_b16 v[206:207], v39 offset:9216
    v_mfma_f32_16x16x32_bf16 v[120:123], v[172:175], v[184:187], v[120:123]
L_hpA7:
    s_cbranch_execz L_hpA_back0
    v_mfma_f32_16x16x32_bf16 v[124:127], v[172:175], v[188:191], v[124:127]
    s_waitcnt lgkmcnt(9)
    v_mfma_f32_16x16x32_bf16 v[64:67], v[192:195], v[208:211], v[64:67]
    s_add_u32 m0, s57, 49152
    s_waitcnt lgkmcnt(8)
    v_mfma_f32_16x16x32_bf16 v[68:71], v[192:195], v[212:215], v[68:71]
    s_waitcnt lgkmcnt(7)
    v_mfma_f32_16x16x32_bf16 v[72:75], v[192:195], v[216:219], v[72:75]
    buffer_load_dwordx4 v18, s[32:35], s70 offen offset:0 lds
    s_waitcnt lgkmcnt(6)
    v_mfma_f32_16x16x32_bf16 v[76:79], v[192:195], v[220:223], v[76:79]
    s_waitcnt lgkmcnt(4)
    v_mfma_f32_16x16x32_bf16 v[80:83], v[196:199], v[208:211], v[80:83]
    buffer_load_dwordx4 v19, s[32:35], s70 offen offset:1024 lds
    v_mfma_f32_16x16x32_bf16 v[84:87], v[196:199], v[212:215], v[84:87]
    v_mfma_f32_16x16x32_bf16 v[88:91], v[196:199], v[216:219], v[88:91]
    buffer_load_dwordx4 v20, s[32:35], s70 offen offset:2048 lds
    v_mfma_f32_16x16x32_bf16 v[92:95], v[196:199], v[220:223], v[92:95]
    s_waitcnt lgkmcnt(2)
    v_mfma_f32_16x16x32_bf16 v[96:99], v[200:203], v[208:211], v[96:99]
    buffer_load_dwordx4 v21, s[32:35], s70 offen offset:3072 lds
    v_mfma_f32_16x16x32_bf16 v[100:103], v[200:203], v[212:215], v[100:103]
    v_mfma_f32_16x16x32_bf16 v[104:107], v[200:203], v[216:219], v[104:107]
    s_add_u32 s70, s70, 163840
    v_mfma_f32_16x16x32_bf16 v[108:111], v[200:203], v[220:223], v[108:111]
    s_waitcnt lgkmcnt(0)
    v_mfma_f32_16x16x32_bf16 v[112:115], v[204:207], v[208:211], v[112:115]
    s_cmp_eq_u32 s70, 2129920
    s_cselect_b32 s70, 0, s70
    v_mfma_f32_16x16x32_bf16 v[116:119], v[204:207], v[212:215], v[116:119]
    v_mfma_f32_16x16x32_bf16 v[120:123], v[204:207], v[216:219], v[120:123]
    v_mfma_f32_16x16x32_bf16 v[124:127], v[204:207], v[220:223], v[124:127]
    s_barrier
    v_lshlrev_b32 v56, 16, v60
    v_and_b32 v57, 0xffff0000, v60
    v_lshlrev_b32 v58, 16, v61
    v_and_b32 v59, 0xffff0000, v61
L_hpA8:
    s_cbranch_execz L_hpA_back0
    v_pk_mul_f32 v[48:49], v[64:65], v[64:65]
    s_add_u32 m0, s57, 65536
    v_pk_mul_f32 v[50:51], v[66:67], v[66:67]
    v_pk_mul_f32 v[52:53], v[80:81], v[80:81]
    v_pk_mul_f32 v[54:55], v[82:83], v[82:83]
    v_pk_fma_f32 v[48:49], v[48:49], v[44:45], v[42:43]
    v_pk_fma_f32 v[50:51], v[50:51], v[44:45], v[42:43]
    v_pk_fma_f32 v[52:53], v[52:53], v[44:45], v[42:43]
    v_pk_fma_f32 v[54:55], v[54:55], v[44:45], v[42:43]
    v_pk_mul_f32 v[48:49], v[64:65], v[48:49]
    v_pk_mul_f32 v[50:51], v[66:67], v[50:51]
    v_pk_mul_f32 v[52:53], v[80:81], v[52:53]
    buffer_load_dwordx4 v18, s[32:35], s70 offen offset:0 lds
    v_pk_mul_f32 v[54:55], v[82:83], v[54:55]
    v_exp_f32 v48, v48
    v_exp_f32 v49, v49
    v_exp_f32 v50, v50
L_hpA9:
    s_cbranch_execz L_hpA_back0
    v_exp_f32 v51, v51
    v_exp_f32 v52, v52
    v_exp_f32 v53, v53
    v_exp_f32 v54, v54
    v_exp_f32 v55, v55
    v_pk_add_f32 v[48:49], v[48:49], v[46:47]
    buffer_load_dwordx4 v19, s[32:35], s70 offen offset:1024 lds
    v_pk_add_f32 v[50:51], v[50:51], v[46:47]
    v_pk_add_f32 v[52:53], v[52:53], v[46:47]
    v_pk_add_f32 v[54:55], v[54:55], v[46:47]
    v_rcp_f32 v48, v48
    v_rcp_f32 v49, v49
    v_rcp_f32 v50, v50
    v_rcp_f32 v51, v51
    v_rcp_f32 v52, v52
    v_rcp_f32 v53, v53
    v_rcp_f32 v54, v54
    buffer_load_dwordx4 v20, s[32:35], s70 offen offset:2048 lds
    v_rcp_f32 v55, v55
    v_pk_mul_f32 v[48:49], v[64:65], v[48:49]
    v_pk_mul_f32 v[50:51], v[66:67], v[50:51]
    v_pk_mul_f32 v[52:53], v[80:81], v[52:53]
L_hpA10:
    s_cbranch_execz L_hpA_back0
    v_pk_mul_f32 v[54:55], v[82:83], v[54:55]
    v_cvt_pk_bf16_f32 v128, v48, v49
    v_cvt_pk_bf16_f32 v129, v50, v51
    v_cvt_pk_bf16_f32 v130, v52, v53
    v_cvt_pk_bf16_f32 v131, v54, v55
    buffer_store_dwordx4 v[128:131], v40, s[48:51], 0 offen offset:0 sc1
    v_pk_mul_f32 v[48:49], v[96:97], v[96:97]
    buffer_load_dwordx4 v21, s[32:35], s70 offen offset:3072 lds
    v_pk_mul_f32 v[50:51], v[98:99], v[98:99]
    v_pk_mul_f32 v[52:53], v[112:113], v[112:113]
    v_pk_mul_f32 v[54:55], v[114:115], v[114:115]
    v_pk_fma_f32 v[48:49], v[48:49], v[44:45], v[42:43]
    v_pk_fma_f32 v[50:51], v[50:51], v[44:45], v[42:43]
    v_pk_fma_f32 v[52:53], v[52:53], v[44:45], v[42:43]
    v_pk_fma_f32 v[54:55], v[54:55], v[44:45], v[42:43]
    v_pk_mul_f32 v[48:49], v[96:97], v[48:49]
L_hpA11:
    s_cbranch_execz L_hpA_back0
    v_pk_mul_f32 v[50:51], v[98:99], v[50:51]
    v_pk_mul_f32 v[52:53], v[112:113], v[52:53]
    v_pk_mul_f32 v[54:55], v[114:115], v[54:55]
    v_exp_f32 v48, v48
    v_exp_f32 v49, v49
    s_add_u32 s70, s70, 163840
    v_exp_f32 v50, v50
    v_exp_f32 v51, v51
    v_exp_f32 v52, v52
    v_exp_f32 v53, v53
    v_exp_f32 v54, v54
    v_exp_f32 v55, v55
    v_pk_add_f32 v[48:49], v[48:49], v[46:47]
    v_pk_add_f32 v[50:51], v[50:51], v[46:47]
    v_pk_add_f32 v[52:53], v[52:53], v[46:47]
    v_pk_add_f32 v[54:55], v[54:55], v[46:47]
    v_rcp_f32 v48, v48
    v_rcp_f32 v49, v49
    v_rcp_f32 v50, v50
    s_cmp_eq_u32 s70, 2129920
    s_cselect_b32 s70, 0, s70
L_hpA12:
    s_cbranch_execz L_hpA_back0
    v_rcp_f32 v51, v51
    v_rcp_f32 v52, v52
    v_rcp_f32 v53, v53
    v_rcp_f32 v54, v54
    v_rcp_f32 v55, v55
    v_pk_mul_f32 v[48:49], v[96:97], v[48:49]
    v_pk_mul_f32 v[50:51], v[98:99], v[50:51]
    v_pk_mul_f32 v[52:53], v[112:113], v[52:53]
    v_pk_mul_f32 v[54:55], v[114:115], v[54:55]
    v_cvt_pk_bf16_f32 v132, v48, v49
    v_cvt_pk_bf16_f32 v133, v50, v51
    v_cvt_pk_bf16_f32 v134, v52, v53
    v_cvt_pk_bf16_f32 v135, v54, v55
    buffer_store_dwordx4 v[132:135], v40, s[48:51], 0 offen offset:1024 sc1
    v_pk_mul_f32 v[48:49], v[68:69], v[68:69]
    s_add_u32 m0, s57, 81920
    v_pk_mul_f32 v[50:51], v[70:71], v[70:71]
    v_pk_mul_f32 v[52:53], v[84:85], v[84:85]
L_hpA13:
    s_cbranch_execz L_hpA_back0
    v_pk_mul_f32 v[54:55], v[86:87], v[86:87]
    v_pk_fma_f32 v[48:49], v[48:49], v[44:45], v[42:43]
    v_pk_fma_f32 v[50:51], v[50:51], v[44:45], v[42:43]
    v_pk_fma_f32 v[52:53], v[52:53], v[44:45], v[42:43]
    v_pk_fma_f32 v[54:55], v[54:55], v[44:45], v[42:43]
    v_pk_mul_f32 v[48:49], v[68:69], v[48:49]
    v_pk_mul_f32 v[50:51], v[70:71], v[50:51]
    v_pk_mul_f32 v[52:53], v[84:85], v[52:53]
    buffer_load_dwordx4 v18, s[32:35], s70 offen offset:0 lds
    v_pk_mul_f32 v[54:55], v[86:87], v[54:55]
    v_exp_f32 v48, v48
    v_exp_f32 v49, v49
    v_exp_f32 v50, v50
    v_exp_f32 v51, v51
    v_exp_f32 v52, v52
    v_exp_f32 v53, v53
    v_exp_f32 v54, v54
    v_exp_f32 v55, v55
    v_pk_add_f32 v[48:49], v[48:49], v[46:47]
    buffer_load_dwordx4 v19, s[32:35], s70 offen offset:1024 lds
L_hpA14:
    s_cbranch_execz L_hpA_back0
    v_pk_add_f32 v[50:51], v[50:51], v[46:47]
    v_pk_add_f32 v[52:53], v[52:53], v[46:47]
    v_pk_add_f32 v[54:55], v[54:55], v[46:47]
    v_rcp_f32 v48, v48
    v_rcp_f32 v49, v49
    v_rcp_f32 v50, v50
    v_rcp_f32 v51, v51
    v_rcp_f32 v52, v52
    v_rcp_f32 v53, v53
    v_rcp_f32 v54, v54
    buffer_load_dwordx4 v20, s[32:35], s70 offen offset:2048 lds
    v_rcp_f32 v55, v55
    v_pk_mul_f32 v[48:49], v[68:69], v[48:49]
    v_pk_mul_f32 v[50:51], v[70:71], v[50:51]
    v_pk_mul_f32 v[52:53], v[84:85], v[52:53]
    v_pk_mul_f32 v[54:55], v[86:87], v[54:55]
    v_cvt_pk_bf16_f32 v136, v48, v49
    v_cvt_pk_bf16_f32 v137, v50, v51
    v_cvt_pk_bf16_f32 v138, v52, v53
L_hpA15:
    s_cbranch_execz L_hpA_back0
    v_cvt_pk_bf16_f32 v139, v54, v55
    buffer_store_dwordx4 v[136:139], v40, s[48:51], s76 offen offset:0 sc1
    v_pk_mul_f32 v[48:49], v[100:101], v[100:101]
    buffer_load_dwordx4 v21, s[32:35], s70 offen offset:3072 lds
    v_pk_mul_f32 v[50:51], v[102:103], v[102:103]
    v_pk_mul_f32 v[52:53], v[116:117], v[116:117]
    v_pk_mul_f32 v[54:55], v[118:119], v[118:119]
    v_pk_fma_f32 v[48:49], v[48:49], v[44:45], v[42:43]
    v_pk_fma_f32 v[50:51], v[50:51], v[44:45], v[42:43]
    v_pk_fma_f32 v[52:53], v[52:53], v[44:45], v[42:43]
    v_pk_fma_f32 v[54:55], v[54:55], v[44:45], v[42:43]
    v_pk_mul_f32 v[48:49], v[100:101], v[48:49]
    v_pk_mul_f32 v[50:51], v[102:103], v[50:51]
    v_pk_mul_f32 v[52:53], v[116:117], v[52:53]
    v_pk_mul_f32 v[54:55], v[118:119], v[54:55]
    v_exp_f32 v48, v48
L_hpA16:
    s_cbranch_execz L_hpA_back0
    v_exp_f32 v49, v49
    s_add_u32 s70, s70, 163840
    v_exp_f32 v50, v50
    v_exp_f32 v51, v51
    v_exp_f32 v52, v52
    v_exp_f32 v53, v53
    v_exp_f32 v54, v54
    v_exp_f32 v55, v55
    v_pk_add_f32 v[48:49], v[48:49], v[46:47]
    v_pk_add_f32 v[50:51], v[50:51], v[46:47]
    v_pk_add_f32 v[52:53], v[52:53], v[46:47]
    v_pk_add_f32 v[54:55], v[54:55], v[46:47]
    v_rcp_f32 v48, v48
    v_rcp_f32 v49, v49
    v_rcp_f32 v50, v50
    s_cmp_eq_u32 s70, 2129920
    s_cselect_b32 s70, 0, s70
    v_rcp_f32 v51, v51
    v_rcp_f32 v52, v52
    v_rcp_f32 v53, v53
    v_rcp_f32 v54, v54
    v_rcp_f32 v55, v55
    v_pk_mul_f32 v[48:49], v[100:101], v[48:49]
    v_pk_mul_f32 v[50:51], v[102:103], v[50:51]
L_hpA17:
    s_cbranch_execz L_hpA_back0
    v_pk_mul_f32 v[52:53], v[116:117], v[52:53]
    v_pk_mul_f32 v[54:55], v[118:119], v[54:55]
    v_cvt_pk_bf16_f32 v140, v48, v49
    v_cvt_pk_bf16_f32 v141, v50, v51
    v_cvt_pk_bf16_f32 v142, v52, v53
    v_cvt_pk_bf16_f32 v143, v54, v55
    buffer_store_dwordx4 v[140:143], v40, s[48:51], s76 offen offset:1024 sc1
    v_pk_mul_f32 v[48:49], v[72:73], v[72:73]
    s_add_u32 m0, s57, 98304
    v_pk_mul_f32 v[50:51], v[74:75], v[74:75]
    v_pk_mul_f32 v[52:53], v[88:89], v[88:89]
    v_pk_mul_f32 v[54:55], v[90:91], v[90:91]
    v_pk_fma_f32 v[48:49], v[48:49], v[44:45], v[42:43]
    v_pk_fma_f32 v[50:51], v[50:51], v[44:45], v[42:43]
    v_pk_fma_f32 v[52:53], v[52:53], v[44:45], v[42:43]
L_hpA18:
    s_cbranch_execz L_hpA_back0
    v_pk_fma_f32 v[54:55], v[54:55], v[44:45], v[42:43]
    v_pk_mul_f32 v[48:49], v[72:73], v[48:49]
    v_pk_mul_f32 v[50:51], v[74:75], v[50:51]
    v_pk_mul_f32 v[52:53], v[88:89], v[52:53]
    buffer_load_dwordx4 v18, s[32:35], s70 offen offset:0 lds
    v_pk_mul_f32 v[54:55], v[90:91], v[54:55]
    v_exp_f32 v48, v48
    v_exp_f32 v49, v49
    v_exp_f32 v50, v50
    v_exp_f32 v51, v51
    v_exp_f32 v52, v52
    v_exp_f32 v53, v53
    v_exp_f32 v54, v54
    v_exp_f32 v55, v55
    v_pk_add_f32 v[48:49], v[48:49], v[46:47]
    buffer_load_dwordx4 v19, s[32:35], s70 offen offset:1024 lds
    v_pk_add_f32 v[50:51], v[50:51], v[46:47]
    v_pk_add_f32 v[52:53], v[52:53], v[46:47]
    v_pk_add_f32 v[54:55], v[54:55], v[46:47]
    v_rcp_f32 v48, v48
L_hpA19:
    s_cbranch_execz L_hpA_back0
    v_rcp_f32 v49, v49
    v_rcp_f32 v50, v50
    v_rcp_f32 v51, v51
    v_rcp_f32 v52, v52
    v_rcp_f32 v53, v53
    v_rcp_f32 v54, v54
    buffer_load_dwordx4 v20, s[32:35], s70 offen offset:2048 lds
    v_rcp_f32 v55, v55
    v_pk_mul_f32 v[48:49], v[72:73], v[48:49]
    v_pk_mul_f32 v[50:51], v[74:75], v[50:51]
    v_pk_mul_f32 v[52:53], v[88:89], v[52:53]
    v_pk_mul_f32 v[54:55], v[90:91], v[54:55]
    v_cvt_pk_bf16_f32 v128, v48, v49
    v_cvt_pk_bf16_f32 v129, v50, v51
    v_cvt_pk_bf16_f32 v130, v52, v53
    v_cvt_pk_bf16_f32 v131, v54, v55
    buffer_store_dwordx4 v[128:131], v40, s[48:51], s77 offen offset:0 sc1
    v_pk_mul_f32 v[48:49], v[104:105], v[104:105]
    buffer_load_dwordx4 v21, s[32:35], s70 offen offset:3072 lds
L_hpA20:
    s_cbranch_execz L_hpA_back0
    v_pk_mul_f32 v[50:51], v[106:107], v[106:107]
    v_pk_mul_f32 v[52:53], v[120:121], v[120:121]
    v_pk_mul_f32 v[54:55], v[122:123], v[122:123]
    v_pk_fma_f32 v[48:49], v[48:49], v[44:45], v[42:43]
    v_pk_fma_f32 v[50:51], v[50:51], v[44:45], v[42:43]
    v_pk_fma_f32 v[52:53], v[52:53], v[44:45], v[42:43]
    v_pk_fma_f32 v[54:55], v[54:55], v[44:45], v[42:43]
    v_pk_mul_f32 v[48:49], v[104:105], v[48:49]
    v_pk_mul_f32 v[50:51], v[106:107], v[50:51]
    v_pk_mul_f32 v[52:53], v[120:121], v[52:53]
    v_pk_mul_f32 v[54:55], v[122:123], v[54:55]
    v_exp_f32 v48, v48
    v_exp_f32 v49, v49
    s_add_u32 s70, s70, 163840
    v_exp_f32 v50, v50
    v_exp_f32 v51, v51
    v_exp_f32 v52, v52
    v_exp_f32 v53, v53
    v_exp_f32 v54, v54
L_hpA21:
    s_cbranch_execz L_hpA_back0
    v_exp_f32 v55, v55
    v_pk_add_f32 v[48:49], v[48:49], v[46:47]
    v_pk_add_f32 v[50:51], v[50:51], v[46:47]
    v_pk_add_f32 v[52:53], v[52:53], v[46:47]
    v_pk_add_f32 v[54:55], v[54:55], v[46:47]
    v_rcp_f32 v48, v48
    v_rcp_f32 v49, v49
    v_rcp_f32 v50, v50
    s_cmp_eq_u32 s70, 2129920
    s_cselect_b32 s70, 0, s70
    v_rcp_f32 v51, v51
    v_rcp_f32 v52, v52
    v_rcp_f32 v53, v53
    v_rcp_f32 v54, v54
    v_rcp_f32 v55, v55
    v_pk_mul_f32 v[48:49], v[104:105], v[48:49]
    v_pk_mul_f32 v[50:51], v[106:107], v[50:51]
    v_pk_mul_f32 v[52:53], v[120:121], v[52:53]
    v_pk_mul_f32 v[54:55], v[122:123], v[54:55]
    v_cvt_pk_bf16_f32 v132, v48, v49
    v_cvt_pk_bf16_f32 v133, v50, v51
L_hpA22:
    s_cbranch_execz L_hpA_back0
    v_cvt_pk_bf16_f32 v134, v52, v53
    v_cvt_pk_bf16_f32 v135, v54, v55
    buffer_store_dwordx4 v[132:135], v40, s[48:51], s77 offen offset:1024 sc1
    s_waitcnt vmcnt(31)
    v_cmp_gt_u32 vcc, 32, v244
    s_cbranch_vccz L_dbg_ok
    s_mov_b32 s74, 0
L_dbg:
    v_mov_b32 v2, 0
    buffer_load_dword v244, v2, s[44:47], 0 offen sc1
    s_waitcnt vmcnt(0)
    v_cmp_gt_u32 vcc, 32, v244
    s_cbranch_vccz L_dbg_ok
    s_sleep 4
    s_add_u32 s74, s74, 1
    s_cmp_lt_u32 s74, 200000
    s_cbranch_scc1 L_dbg
L_dbg_ok:
    v_mov_b32 v3, 1
    s_waitcnt vmcnt(6)
    s_mov_b64 exec, 1
    buffer_atomic_add v3, v250, s[52:55], 0 offen offset:0 sc1
    s_mov_b64 exec, -1
    v_pk_mul_f32 v[48:49], v[76:77], v[76:77]
    s_add_u32 m0, s57, 114688
L_hpA23:
    s_cbranch_execz L_hpA_back0
    v_pk_mul_f32 v[50:51], v[78:79], v[78:79]
    v_pk_mul_f32 v[52:53], v[92:93], v[92:93]
    v_pk_mul_f32 v[54:55], v[94:95], v[94:95]
    v_pk_fma_f32 v[48:49], v[48:49], v[44:45], v[42:43]
    v_pk_fma_f32 v[50:51], v[50:51], v[44:45], v[42:43]
    v_pk_fma_f32 v[52:53], v[52:53], v[44:45], v[42:43]
    v_pk_fma_f32 v[54:55], v[54:55], v[44:45], v[42:43]
    v_pk_mul_f32 v[48:49], v[76:77], v[48:49]
    v_pk_mul_f32 v[50:51], v[78:79], v[50:51]
    v_pk_mul_f32 v[52:53], v[92:93], v[52:53]
    buffer_load_dwordx4 v18, s[32:35], s70 offen offset:0 lds
    v_pk_mul_f32 v[54:55], v[94:95], v[54:55]
    v_exp_f32 v48, v48
    v_exp_f32 v49, v49
    v_exp_f32 v50, v50
    v_exp_f32 v51, v51
    v_exp_f32 v52, v52
    v_exp_f32 v53, v53
L_hpA24:
    s_cbranch_execz L_hpA_back0
    v_exp_f32 v54, v54
    v_exp_f32 v55, v55
    v_pk_add_f32 v[48:49], v[48:49], v[46:47]
    buffer_load_dwordx4 v19, s[32:35], s70 offen offset:1024 lds
    v_pk_add_f32 v[50:51], v[50:51], v[46:47]
    v_pk_add_f32 v[52:53], v[52:53], v[46:47]
    v_pk_add_f32 v[54:55], v[54:55], v[46:47]
    v_rcp_f32 v48, v48
    v_rcp_f32 v49, v49
    v_rcp_f32 v50, v50
    v_rcp_f32 v51, v51
    v_rcp_f32 v52, v52
    v_rcp_f32 v53, v53
    v_rcp_f32 v54, v54
    buffer_load_dwordx4 v20, s[32:35], s70 offen offset:2048 lds
    v_rcp_f32 v55, v55
    v_pk_mul_f32 v[48:49], v[76:77], v[48:49]
    v_pk_mul_f32 v[50:51], v[78:79], v[50:51]
    v_pk_mul_f32 v[52:53], v[92:93], v[52:53]
    v_pk_mul_f32 v[54:55], v[94:95], v[54:55]
    v_cvt_pk_bf16_f32 v136, v48, v49
L_hpA25:
    s_cbranch_execz L_hpA_back0
    v_cvt_pk_bf16_f32 v137, v50, v51
    v_cvt_pk_bf16_f32 v138, v52, v53
    v_cvt_pk_bf16_f32 v139, v54, v55
    buffer_store_dwordx4 v[136:139], v40, s[48:51], s78 offen offset:0 sc1
    v_pk_mul_f32 v[48:49], v[108:109], v[108:109]
    buffer_load_dwordx4 v21, s[32:35], s70 offen offset:3072 lds
    v_pk_mul_f32 v[50:51], v[110:111], v[110:111]
    v_pk_mul_f32 v[52:53], v[124:125], v[124:125]
    v_pk_mul_f32 v[54:55], v[126:127], v[126:127]
    v_pk_fma_f32 v[48:49], v[48:49], v[44:45], v[42:43]
    v_pk_fma_f32 v[50:51], v[50:51], v[44:45], v[42:43]
    v_pk_fma_f32 v[52:53], v[52:53], v[44:45], v[42:43]
    v_pk_fma_f32 v[54:55], v[54:55], v[44:45], v[42:43]
    v_pk_mul_f32 v[48:49], v[108:109], v[48:49]
    v_pk_mul_f32 v[50:51], v[110:111], v[50:51]
L_hpA26:
    s_cbranch_execz L_hpA_back0
    v_pk_mul_f32 v[52:53], v[124:125], v[52:53]
    v_pk_mul_f32 v[54:55], v[126:127], v[54:55]
    v_exp_f32 v48, v48
    v_exp_f32 v49, v49
    s_add_u32 s70, s70, 163840
    v_exp_f32 v50, v50
    v_exp_f32 v51, v51
    v_exp_f32 v52, v52
    v_exp_f32 v53, v53
    v_exp_f32 v54, v54
    v_exp_f32 v55, v55
    v_pk_add_f32 v[48:49], v[48:49], v[46:47]
    v_pk_add_f32 v[50:51], v[50:51], v[46:47]
    v_pk_add_f32 v[52:53], v[52:53], v[46:47]
    v_pk_add_f32 v[54:55], v[54:55], v[46:47]
    v_rcp_f32 v48, v48
    v_rcp_f32 v49, v49
    v_rcp_f32 v50, v50
    s_cmp_eq_u32 s70, 2129920
    s_cselect_b32 s70, 0, s70
    v_rcp_f32 v51, v51
    v_rcp_f32 v52, v52
    v_rcp_f32 v53, v53
L_hpA27:
    s_cbranch_execz L_hpA_back0
    v_rcp_f32 v54, v54
    v_rcp_f32 v55, v55
    v_pk_mul_f32 v[48:49], v[108:109], v[48:49]
    v_pk_mul_f32 v[50:51], v[110:111], v[50:51]
    v_pk_mul_f32 v[52:53], v[124:125], v[52:53]
    v_pk_mul_f32 v[54:55], v[126:127], v[54:55]
    v_cvt_pk_bf16_f32 v140, v48, v49
    v_cvt_pk_bf16_f32 v141, v50, v51
    v_cvt_pk_bf16_f32 v142, v52, v53
    v_cvt_pk_bf16_f32 v143, v54, v55
    buffer_store_dwordx4 v[140:143], v40, s[48:51], s78 offen offset:1024 sc1
    ds_read_b64_tr_b16 a[0:1], v224 offset:0
    ds_read_b64_tr_b16 a[2:3], v224 offset:2048
    ds_read_b64_tr_b16 a[4:5], v225 offset:0
    ds_read_b64_tr_b16 a[6:7], v225 offset:2048
    ds_read_b64_tr_b16 a[8:9], v226 offset:0
    ds_read_b64_tr_b16 a[10:11], v226 offset:2048
L_hpA28:
    s_cbranch_execz L_hpA_back0
    ds_read_b64_tr_b16 a[12:13], v227 offset:0
    ds_read_b64_tr_b16 a[14:15], v227 offset:2048
    ds_read_b64_tr_b16 a[16:17], v224 offset:16384
    ds_read_b64_tr_b16 a[18:19], v224 offset:18432
    ds_read_b64_tr_b16 a[20:21], v225 offset:16384
    ds_read_b64_tr_b16 a[22:23], v225 offset:18432
    ds_read_b64_tr_b16 a[24:25], v226 offset:16384
    ds_read_b64_tr_b16 a[26:27], v226 offset:18432
    ds_read_b64_tr_b16 a[28:29], v227 offset:16384
    ds_read_b64_tr_b16 a[30:31], v227 offset:18432
    ds_read_b64_tr_b16 a[32:33], v224 offset:32768
    ds_read_b64_tr_b16 a[34:35], v224 offset:34816
    ds_read_b64_tr_b16 a[36:37], v225 offset:32768
    ds_read_b64_tr_b16 a[38:39], v225 offset:34816
    ds_read_b64_tr_b16 a[40:41], v226 offset:32768
L_hpA29:
    s_cbranch_execz L_hpA_back0
    ds_read_b64_tr_b16 a[42:43], v226 offset:34816
    ds_read_b64_tr_b16 a[44:45], v227 offset:32768
    ds_read_b64_tr_b16 a[46:47], v227 offset:34816
    ds_read_b64_tr_b16 a[48:49], v224 offset:49152
    ds_read_b64_tr_b16 a[50:51], v224 offset:51200
    ds_read_b64_tr_b16 a[52:53], v225 offset:49152
    ds_read_b64_tr_b16 a[54:55], v225 offset:51200
    ds_read_b64_tr_b16 a[56:57], v226 offset:49152
    ds_read_b64_tr_b16 a[58:59], v226 offset:51200
    ds_read_b64_tr_b16 a[60:61], v227 offset:49152
    ds_read_b64_tr_b16 a[62:63], v227 offset:51200
    s_add_u32 m0, s57, 131072
    s_nop 0
    buffer_load_dwordx4 v18, s[32:35], s70 offen offset:0 lds
    buffer_load_dwordx4 v19, s[32:35], s70 offen offset:1024 lds
    buffer_load_dwordx4 v20, s[32:35], s70 offen offset:2048 lds
L_pg2:
    s_cbranch_execz L_pg_back
L_hpA30:
    s_cbranch_execz L_hpA_back0
    buffer_load_dwordx4 v21, s[32:35], s70 offen offset:3072 lds
    s_add_u32 s70, s70, 163840
    s_cmp_eq_u32 s70, 2129920
    s_cselect_b32 s70, 0, s70
    s_add_u32 m0, s57, 147456
    s_nop 0
    buffer_load_dwordx4 v18, s[32:35], s70 offen offset:0 lds
    buffer_load_dwordx4 v19, s[32:35], s70 offen offset:1024 lds
    buffer_load_dwordx4 v20, s[32:35], s70 offen offset:2048 lds
    buffer_load_dwordx4 v21, s[32:35], s70 offen offset:3072 lds
    s_add_u32 s70, s70, 163840
    s_cmp_eq_u32 s70, 2129920
    s_cselect_b32 s70, 0, s70
    v_mov_b32 v251, 0
    s_mov_b64 exec, 3
    buffer_atomic_add v251, v243, s[52:55], 0 offen offset:0 sc0 sc1
    s_mov_b64 exec, -1
    s_waitcnt lgkmcnt(15)
    s_add_u32 m0, s57, 0
L_hpA31:
    s_cbranch_execz L_hpA_back0
    s_nop 0
    buffer_load_dwordx4 v18, s[32:35], s70 offen offset:0 lds
    buffer_load_dwordx4 v19, s[32:35], s70 offen offset:1024 lds
    buffer_load_dwordx4 v20, s[32:35], s70 offen offset:2048 lds
    buffer_load_dwordx4 v21, s[32:35], s70 offen offset:3072 lds
    s_add_u32 s70, s70, 163840
    s_cmp_eq_u32 s70, 2129920
    s_cselect_b32 s70, 0, s70
    s_add_u32 m0, s57, 16384
    s_nop 0
    buffer_load_dwordx4 v18, s[32:35], s70 offen offset:0 lds
    buffer_load_dwordx4 v19, s[32:35], s70 offen offset:1024 lds
    buffer_load_dwordx4 v20, s[32:35], s70 offen offset:2048 lds
    buffer_load_dwordx4 v21, s[32:35], s70 offen offset:3072 lds
    s_add_u32 s70, s70, 163840
    s_cmp_eq_u32 s70, 2129920
    s_cselect_b32 s70, 0, s70
    s_waitcnt lgkmcnt(8)
L_hpA32:
    s_cbranch_execz L_hpA_back0
    s_add_u32 m0, s57, 32768
    s_nop 0
    buffer_load_dwordx4 v18, s[32:35], s70 offen offset:0 lds
    buffer_load_dwordx4 v19, s[32:35], s70 offen offset:1024 lds
    buffer_load_dwordx4 v20, s[32:35], s70 offen offset:2048 lds
    buffer_load_dwordx4 v21, s[32:35], s70 offen offset:3072 lds
    s_waitcnt lgkmcnt(0)
    v_add_u32 v18, s71, v18
    v_add_u32 v19, s71, v19
    v_add_u32 v20, s71, v20
    v_add_u32 v21, s71, v21
    s_mov_b32 s70, 2129920
    s_add_u32 m0, s57, 49152
    s_nop 0
    buffer_load_dwordx4 v18, s[32:35], s70 offen offset:0 lds
    buffer_load_dwordx4 v19, s[32:35], s70 offen offset:1024 lds
    buffer_load_dwordx4 v20, s[32:35], s70 offen offset:2048 lds
    buffer_load_dwordx4 v21, s[32:35], s70 offen offset:3072 lds
    ds_read_b64_tr_b16 a[64:65], v228 offset:0
L_hpA33:
    s_cbranch_execz L_hpA_back0
    ds_read_b64_tr_b16 a[66:67], v228 offset:2048
    ds_read_b64_tr_b16 a[68:69], v229 offset:0
    ds_read_b64_tr_b16 a[70:71], v229 offset:2048
    ds_read_b64_tr_b16 a[72:73], v230 offset:0
    ds_read_b64_tr_b16 a[74:75], v230 offset:2048
    ds_read_b64_tr_b16 a[76:77], v231 offset:0
    ds_read_b64_tr_b16 a[78:79], v231 offset:2048
    ds_read_b64_tr_b16 a[80:81], v228 offset:16384
    ds_read_b64_tr_b16 a[82:83], v228 offset:18432
    ds_read_b64_tr_b16 a[84:85], v229 offset:16384
    ds_read_b64_tr_b16 a[86:87], v229 offset:18432
    ds_read_b64_tr_b16 a[88:89], v230 offset:16384
    ds_read_b64_tr_b16 a[90:91], v230 offset:18432
    ds_read_b64_tr_b16 a[92:93], v231 offset:16384
    ds_read_b64_tr_b16 a[94:95], v231 offset:18432
    v_mov_b32 v3, 1
L_hpA34:
    s_cbranch_execz L_hpA_back0
    s_waitcnt vmcnt(25)
    s_mov_b64 exec, 1
    buffer_atomic_add v3, v250, s[52:55], 0 offen offset:128 sc1
    s_mov_b64 exec, -1
    s_cmp_ge_u32 s75, 125
    s_cbranch_scc1 L_fin
    s_waitcnt lgkmcnt(0)
    s_cmp_lg_u32 s56, 0
    s_cbranch_scc1 L_pollA_ok
    s_mov_b64 exec, 3
    s_waitcnt vmcnt(17)
    v_cmp_gt_u32 vcc, 27, v251
    s_mov_b64 exec, -1
    s_cbranch_vccz L_pollA_ok
    s_mov_b32 s74, 0
L_pollA:
    v_mov_b32 v251, 0
    s_mov_b64 exec, 3
    buffer_atomic_add v251, v243, s[52:55], 0 offen offset:0 sc0 sc1
    s_mov_b64 exec, -1
    s_waitcnt vmcnt(0)
    s_mov_b64 exec, 3
    v_cmp_gt_u32 vcc, 27, v251
    s_mov_b64 exec, -1
    s_cbranch_vccz L_pollA_ok
    s_sleep 4
    s_add_u32 s74, s74, 1
    s_cmp_lt_u32 s74, 200000
L_hpA35:
    s_cbranch_execz L_hpA_back0
    s_cbranch_scc1 L_pollA
L_pollA_ok:
    s_barrier
    v_add_u32 v236, s88, v246
    v_add_u32 v237, s88, v247
    buffer_load_dwordx4 v[160:163], v236, s[48:51], s4 offen sc1
    buffer_load_dwordx4 v[164:167], v236, s[48:51], s5 offen sc1
    buffer_load_dwordx4 v[168:171], v236, s[48:51], s6 offen sc1
    buffer_load_dwordx4 v[172:175], v236, s[48:51], s7 offen sc1
    buffer_load_dwordx4 v[176:179], v236, s[48:51], s8 offen sc1
    buffer_load_dwordx4 v[180:183], v236, s[48:51], s9 offen sc1
    buffer_load_dwordx4 v[184:187], v236, s[48:51], s10 offen sc1
    buffer_load_dwordx4 v[188:191], v236, s[48:51], s11 offen sc1
    ds_read_b64_tr_b16 a[96:97], v228 offset:32768
    ds_read_b64_tr_b16 a[98:99], v228 offset:34816
    ds_read_b64_tr_b16 a[100:101], v229 offset:32768
    ds_read_b64_tr_b16 a[102:103], v229 offset:34816
    ds_read_b64_tr_b16 a[104:105], v230 offset:32768
    ds_read_b64_tr_b16 a[106:107], v230 offset:34816
L_hpA36:
    s_cbranch_execz L_hpA_back0
    ds_read_b64_tr_b16 a[108:109], v231 offset:32768
    ds_read_b64_tr_b16 a[110:111], v231 offset:34816
    ds_read_b64_tr_b16 a[112:113], v228 offset:49152
    ds_read_b64_tr_b16 a[114:115], v228 offset:51200
    ds_read_b64_tr_b16 a[116:117], v229 offset:49152
    ds_read_b64_tr_b16 a[118:119], v229 offset:51200
    ds_read_b64_tr_b16 a[120:121], v230 offset:49152
    ds_read_b64_tr_b16 a[122:123], v230 offset:51200
    ds_read_b64_tr_b16 a[124:125], v231 offset:49152
    ds_read_b64_tr_b16 a[126:127], v231 offset:51200
    s_waitcnt vmcnt(30)
    ds_read_b64_tr_b16 a[128:129], v232 offset:0
    ds_read_b64_tr_b16 a[130:131], v232 offset:2048
    ds_read_b64_tr_b16 a[132:133], v233 offset:0
    ds_read_b64_tr_b16 a[134:135], v233 offset:2048
    ds_read_b64_tr_b16 a[136:137], v234 offset:0
L_hpA37:
    s_cbranch_execz L_hpA_back0
    ds_read_b64_tr_b16 a[138:139], v234 offset:2048
    ds_read_b64_tr_b16 a[140:141], v235 offset:0
    ds_read_b64_tr_b16 a[142:143], v235 offset:2048
    s_waitcnt vmcnt(26)
    ds_read_b64_tr_b16 a[144:145], v232 offset:16384
    ds_read_b64_tr_b16 a[146:147], v232 offset:18432
    ds_read_b64_tr_b16 a[148:149], v233 offset:16384
    ds_read_b64_tr_b16 a[150:151], v233 offset:18432
    ds_read_b64_tr_b16 a[152:153], v234 offset:16384
    ds_read_b64_tr_b16 a[154:155], v234 offset:18432
    ds_read_b64_tr_b16 a[156:157], v235 offset:16384
    ds_read_b64_tr_b16 a[158:159], v235 offset:18432
    s_waitcnt vmcnt(21)
    ds_read_b64_tr_b16 a[160:161], v224 offset:0
    ds_read_b64_tr_b16 a[162:163], v224 offset:2048
    ds_read_b64_tr_b16 a[164:165], v225 offset:0
L_hpA38:
    s_cbranch_execz L_hpA_back0
    ds_read_b64_tr_b16 a[166:167], v225 offset:2048
    ds_read_b64_tr_b16 a[168:169], v226 offset:0
    ds_read_b64_tr_b16 a[170:171], v226 offset:2048
    ds_read_b64_tr_b16 a[172:173], v227 offset:0
    ds_read_b64_tr_b16 a[174:175], v227 offset:2048
    s_waitcnt vmcnt(17)
    ds_read_b64_tr_b16 a[176:177], v224 offset:16384
    ds_read_b64_tr_b16 a[178:179], v224 offset:18432
    ds_read_b64_tr_b16 a[180:181], v225 offset:16384
    ds_read_b64_tr_b16 a[182:183], v225 offset:18432
    ds_read_b64_tr_b16 a[184:185], v226 offset:16384
    ds_read_b64_tr_b16 a[186:187], v226 offset:18432
    ds_read_b64_tr_b16 a[188:189], v227 offset:16384
    ds_read_b64_tr_b16 a[190:191], v227 offset:18432
    s_waitcnt vmcnt(13)
    ds_read_b64_tr_b16 a[192:193], v224 offset:32768
    ds_read_b64_tr_b16 a[194:195], v224 offset:34816
L_hpA39:
    s_cbranch_execz L_hpA_back0
    ds_read_b64_tr_b16 a[196:197], v225 offset:32768
    ds_read_b64_tr_b16 a[198:199], v225 offset:34816
    ds_read_b64_tr_b16 a[200:201], v226 offset:32768
    ds_read_b64_tr_b16 a[202:203], v226 offset:34816
    ds_read_b64_tr_b16 a[204:205], v227 offset:32768
    ds_read_b64_tr_b16 a[206:207], v227 offset:34816
    s_waitcnt vmcnt(9)
    ds_read_b64_tr_b16 a[208:209], v224 offset:49152
    ds_read_b64_tr_b16 a[210:211], v224 offset:51200
    ds_read_b64_tr_b16 a[212:213], v225 offset:49152
    ds_read_b64_tr_b16 a[214:215], v225 offset:51200
    ds_read_b64_tr_b16 a[216:217], v226 offset:49152
    ds_read_b64_tr_b16 a[218:219], v226 offset:51200
    ds_read_b64_tr_b16 a[220:221], v227 offset:49152
    ds_read_b64_tr_b16 a[222:223], v227 offset:51200
    s_waitcnt vmcnt(7)
    v_mfma_f32_16x16x32_bf16 v[64:67], a[0:3], v[160:163], 0
    buffer_load_dwordx4 v[192:195], v236, s[48:51], s12 offen sc1
    v_mfma_f32_16x16x32_bf16 v[68:71], a[4:7], v[160:163], 0
    v_mfma_f32_16x16x32_bf16 v[72:75], a[8:11], v[160:163], 0
    buffer_load_dwordx4 v[196:199], v236, s[48:51], s13 offen sc1
    v_mfma_f32_16x16x32_bf16 v[76:79], a[12:15], v[160:163], 0
    s_waitcnt vmcnt(8)
    v_mfma_f32_16x16x32_bf16 v[64:67], a[16:19], v[164:167], v[64:67]
    buffer_load_dwordx4 v[200:203], v236, s[48:51], s14 offen sc1
    v_mfma_f32_16x16x32_bf16 v[68:71], a[20:23], v[164:167], v[68:71]
    v_mfma_f32_16x16x32_bf16 v[72:75], a[24:27], v[164:167], v[72:75]
    buffer_load_dwordx4 v[204:207], v236, s[48:51], s15 offen sc1
    v_mfma_f32_16x16x32_bf16 v[76:79], a[28:31], v[164:167], v[76:79]
    s_waitcnt vmcnt(9)
    v_mfma_f32_16x16x32_bf16 v[64:67], a[32:35], v[168:171], v[64:67]
    buffer_load_dwordx4 v[208:211], v236, s[48:51], s16 offen sc1
    v_mfma_f32_16x16x32_bf16 v[68:71], a[36:39], v[168:171], v[68:71]
    v_mfma_f32_16x16x32_bf16 v[72:75], a[40:43], v[168:171], v[72:75]
    v_mfma_f32_16x16x32_bf16 v[76:79], a[44:47], v[168:171], v[76:79]
    s_waitcnt vmcnt(9)
    v_mfma_f32_16x16x32_bf16 v[64:67], a[48:51], v[172:175], v[64:67]
    buffer_load_dwordx4 v[212:215], v237, s[48:51], s17 offen sc1
    v_mfma_f32_16x16x32_bf16 v[68:71], a[52:55], v[172:175], v[68:71]
    v_mfma_f32_16x16x32_bf16 v[72:75], a[56:59], v[172:175], v[72:75]
    v_mfma_f32_16x16x32_bf16 v[76:79], a[60:63], v[172:175], v[76:79]
    s_waitcnt vmcnt(9)
    v_mfma_f32_16x16x32_bf16 v[64:67], a[64:67], v[176:179], v[64:67]
    v_add_u32 v236, s89, v246
    v_mfma_f32_16x16x32_bf16 v[68:71], a[68:71], v[176:179], v[68:71]
    v_add_u32 v237, s89, v247
    v_mfma_f32_16x16x32_bf16 v[72:75], a[72:75], v[176:179], v[72:75]
    buffer_load_dwordx4 v[160:163], v236, s[48:51], s4 offen sc1
    v_mfma_f32_16x16x32_bf16 v[76:79], a[76:79], v[176:179], v[76:79]
    s_waitcnt vmcnt(9)
    v_mfma_f32_16x16x32_bf16 v[64:67], a[80:83], v[180:183], v[64:67]
    buffer_load_dwordx4 v[164:167], v236, s[48:51], s5 offen sc1
    v_mfma_f32_16x16x32_bf16 v[68:71], a[84:87], v[180:183], v[68:71]
    v_mfma_f32_16x16x32_bf16 v[72:75], a[88:91], v[180:183], v[72:75]
    v_mfma_f32_16x16x32_bf16 v[76:79], a[92:95], v[180:183], v[76:79]
    s_waitcnt vmcnt(9) lgkmcnt(15)
    v_mfma_f32_16x16x32_bf16 v[64:67], a[96:99], v[184:187], v[64:67]
    buffer_load_dwordx4 v[168:171], v236, s[48:51], s6 offen sc1
    v_mfma_f32_16x16x32_bf16 v[68:71], a[100:103], v[184:187], v[68:71]
    v_mfma_f32_16x16x32_bf16 v[72:75], a[104:107], v[184:187], v[72:75]
    v_mfma_f32_16x16x32_bf16 v[76:79], a[108:111], v[184:187], v[76:79]
    s_waitcnt vmcnt(9)
    v_mfma_f32_16x16x32_bf16 v[64:67], a[112:115], v[188:191], v[64:67]
    buffer_load_dwordx4 v[172:175], v236, s[48:51], s7 offen sc1
    v_mfma_f32_16x16x32_bf16 v[68:71], a[116:119], v[188:191], v[68:71]
    v_mfma_f32_16x16x32_bf16 v[72:75], a[120:123], v[188:191], v[72:75]
    v_mfma_f32_16x16x32_bf16 v[76:79], a[124:127], v[188:191], v[76:79]
    s_waitcnt vmcnt(9)
    v_mfma_f32_16x16x32_bf16 v[64:67], a[128:131], v[192:195], v[64:67]
    buffer_load_dwordx4 v[176:179], v236, s[48:51], s8 offen sc1
    v_mfma_f32_16x16x32_bf16 v[68:71], a[132:135], v[192:195], v[68:71]
    v_mfma_f32_16x16x32_bf16 v[72:75], a[136:139], v[192:195], v[72:75]
    v_mfma_f32_16x16x32_bf16 v[76:79], a[140:143], v[192:195], v[76:79]
    s_waitcnt vmcnt(9)
    v_mfma_f32_16x16x32_bf16 v[64:67], a[144:147], v[196:199], v[64:67]
    buffer_load_dwordx4 v[180:183], v236, s[48:51], s9 offen sc1
    v_mfma_f32_16x16x32_bf16 v[68:71], a[148:151], v[196:199], v[68:71]
    v_mfma_f32_16x16x32_bf16 v[72:75], a[152:155], v[196:199], v[72:75]
    v_mfma_f32_16x16x32_bf16 v[76:79], a[156:159], v[196:199], v[76:79]
    s_waitcnt vmcnt(9)
    v_mfma_f32_16x16x32_bf16 v[64:67], a[160:163], v[200:203], v[64:67]
    buffer_load_dwordx4 v[184:187], v236, s[48:51], s10 offen sc1
    v_mfma_f32_16x16x32_bf16 v[68:71], a[164:167], v[200:203], v[68:71]
    v_mfma_f32_16x16x32_bf16 v[72:75], a[168:171], v[200:203], v[72:75]
    v_mfma_f32_16x16x32_bf16 v[76:79], a[172:175], v[200:203], v[76:79]
    s_waitcnt vmcnt(9)
    v_mfma_f32_16x16x32_bf16 v[64:67], a[176:179], v[204:207], v[64:67]
    buffer_load_dwordx4 v[188:191], v236, s[48:51], s11 offen sc1
    v_mfma_f32_16x16x32_bf16 v[68:71], a[180:183], v[204:207], v[68:71]
    v_mfma_f32_16x16x32_bf16 v[72:75], a[184:187], v[204:207], v[72:75]
    v_mfma_f32_16x16x32_bf16 v[76:79], a[188:191], v[204:207], v[76:79]
    s_waitcnt vmcnt(9) lgkmcnt(14)
    v_mfma_f32_16x16x32_bf16 v[64:67], a[192:195], v[208:211], v[64:67]
    v_mov_b32 v251, 0
    s_mov_b64 exec, 3
    buffer_atomic_add v251, v249, s[52:55], 0 offen offset:128 sc0 sc1
    s_mov_b64 exec, -1
    s_waitcnt lgkmcnt(12)
    v_mfma_f32_16x16x32_bf16 v[68:71], a[196:199], v[208:211], v[68:71]
    s_waitcnt lgkmcnt(10)
    v_mfma_f32_16x16x32_bf16 v[72:75], a[200:203], v[208:211], v[72:75]
    buffer_load_dwordx4 v[192:195], v236, s[48:51], s12 offen sc1
    s_waitcnt lgkmcnt(8)
    v_mfma_f32_16x16x32_bf16 v[76:79], a[204:207], v[208:211], v[76:79]
    s_waitcnt vmcnt(10) lgkmcnt(6)
    v_mfma_f32_16x16x32_bf16 v[64:67], a[208:211], v[212:215], v[64:67]
    buffer_load_dwordx4 v[196:199], v236, s[48:51], s13 offen sc1
    s_waitcnt lgkmcnt(4)
    v_mfma_f32_16x16x32_bf16 v[68:71], a[212:215], v[212:215], v[68:71]
    s_waitcnt lgkmcnt(2)
    v_mfma_f32_16x16x32_bf16 v[72:75], a[216:219], v[212:215], v[72:75]
    s_waitcnt lgkmcnt(0)
    v_mfma_f32_16x16x32_bf16 v[76:79], a[220:223], v[212:215], v[76:79]
    s_waitcnt vmcnt(10)
    v_mfma_f32_16x16x32_bf16 v[80:83], a[0:3], v[160:163], 0
    buffer_load_dwordx4 v[200:203], v236, s[48:51], s14 offen sc1
    v_mfma_f32_16x16x32_bf16 v[84:87], a[4:7], v[160:163], 0
    v_mfma_f32_16x16x32_bf16 v[88:91], a[8:11], v[160:163], 0
    v_mfma_f32_16x16x32_bf16 v[92:95], a[12:15], v[160:163], 0
    s_waitcnt vmcnt(10)
    v_mfma_f32_16x16x32_bf16 v[80:83], a[16:19], v[164:167], v[80:83]
    buffer_load_dwordx4 v[204:207], v236, s[48:51], s15 offen sc1
    v_mfma_f32_16x16x32_bf16 v[84:87], a[20:23], v[164:167], v[84:87]
    v_mfma_f32_16x16x32_bf16 v[88:91], a[24:27], v[164:167], v[88:91]
    ds_write_b128 v240, v[64:67] offset:0
L_hpA40:
    s_cbranch_execz L_hpA_back0
    v_mfma_f32_16x16x32_bf16 v[92:95], a[28:31], v[164:167], v[92:95]
    s_waitcnt vmcnt(10)
    v_mfma_f32_16x16x32_bf16 v[80:83], a[32:35], v[168:171], v[80:83]
    buffer_load_dwordx4 v[208:211], v236, s[48:51], s16 offen sc1
    v_mfma_f32_16x16x32_bf16 v[84:87], a[36:39], v[168:171], v[84:87]
    v_mfma_f32_16x16x32_bf16 v[88:91], a[40:43], v[168:171], v[88:91]
    ds_write_b128 v241, v[68:71] offset:0
    v_mfma_f32_16x16x32_bf16 v[92:95], a[44:47], v[168:171], v[92:95]
    s_waitcnt vmcnt(10)
    v_mfma_f32_16x16x32_bf16 v[80:83], a[48:51], v[172:175], v[80:83]
    buffer_load_dwordx4 v[212:215], v237, s[48:51], s17 offen sc1
    v_mfma_f32_16x16x32_bf16 v[84:87], a[52:55], v[172:175], v[84:87]
    v_mfma_f32_16x16x32_bf16 v[88:91], a[56:59], v[172:175], v[88:91]
    ds_write_b128 v240, v[72:75] offset:128
    v_mfma_f32_16x16x32_bf16 v[92:95], a[60:63], v[172:175], v[92:95]
    s_waitcnt vmcnt(10)
    v_mfma_f32_16x16x32_bf16 v[80:83], a[64:67], v[176:179], v[80:83]
    ds_write_b128 v241, v[76:79] offset:128
    v_mfma_f32_16x16x32_bf16 v[84:87], a[68:71], v[176:179], v[84:87]
    v_mfma_f32_16x16x32_bf16 v[88:91], a[72:75], v[176:179], v[88:91]
    v_mfma_f32_16x16x32_bf16 v[92:95], a[76:79], v[176:179], v[92:95]
    s_waitcnt vmcnt(9)
    v_mfma_f32_16x16x32_bf16 v[80:83], a[80:83], v[180:183], v[80:83]
    v_mfma_f32_16x16x32_bf16 v[84:87], a[84:87], v[180:183], v[84:87]
    v_mfma_f32_16x16x32_bf16 v[88:91], a[88:91], v[180:183], v[88:91]
    v_mfma_f32_16x16x32_bf16 v[92:95], a[92:95], v[180:183], v[92:95]
    s_waitcnt vmcnt(8)
    v_mfma_f32_16x16x32_bf16 v[80:83], a[96:99], v[184:187], v[80:83]
    s_cmp_lg_u32 s56, 0
    s_cbranch_scc1 L_poll1_ok
    s_mov_b64 exec, 3
    s_waitcnt vmcnt(6)
    v_cmp_gt_u32 vcc, 27, v251
    s_mov_b64 exec, -1
    s_cbranch_vccz L_poll1_ok
    s_mov_b32 s74, 0
L_poll1:
    v_mov_b32 v251, 0
    s_mov_b64 exec, 3
    buffer_atomic_add v251, v249, s[52:55], 0 offen offset:128 sc0 sc1
    s_mov_b64 exec, -1
    s_waitcnt vmcnt(0)
    s_mov_b64 exec, 3
    v_cmp_gt_u32 vcc, 27, v251
    s_mov_b64 exec, -1
    s_cbranch_vccz L_poll1_ok
    s_sleep 4
    s_add_u32 s74, s74, 1
    s_cmp_lt_u32 s74, 200000
    s_cbranch_scc1 L_poll1
L_poll1_ok:
    v_mfma_f32_16x16x32_bf16 v[84:87], a[100:103], v[184:187], v[84:87]
    s_waitcnt lgkmcnt(0)
    s_barrier
    v_mfma_f32_16x16x32_bf16 v[88:91], a[104:107], v[184:187], v[88:91]
    ds_read_b128 v[96:99], v242 offset:0
    v_mfma_f32_16x16x32_bf16 v[92:95], a[108:111], v[184:187], v[92:95]
    ds_read_b128 v[100:103], v242 offset:4096
    s_waitcnt vmcnt(7)
    v_mfma_f32_16x16x32_bf16 v[80:83], a[112:115], v[188:191], v[80:83]
    v_add_u32 v236, s90, v246
    v_add_u32 v237, s90, v247
    v_mfma_f32_16x16x32_bf16 v[84:87], a[116:119], v[188:191], v[84:87]
    buffer_load_dwordx4 v[160:163], v236, s[48:51], s4 offen sc1
    v_mfma_f32_16x16x32_bf16 v[88:91], a[120:123], v[188:191], v[88:91]
    buffer_load_dwordx4 v[164:167], v236, s[48:51], s5 offen sc1
    ds_read_b128 v[104:107], v242 offset:8192
    v_mfma_f32_16x16x32_bf16 v[92:95], a[124:127], v[188:191], v[92:95]
    ds_read_b128 v[108:111], v242 offset:12288
    s_waitcnt vmcnt(7)
    v_mfma_f32_16x16x32_bf16 v[80:83], a[128:131], v[192:195], v[80:83]
    buffer_load_dwordx4 v[168:171], v236, s[48:51], s6 offen sc1
    v_mfma_f32_16x16x32_bf16 v[84:87], a[132:135], v[192:195], v[84:87]
    v_mfma_f32_16x16x32_bf16 v[88:91], a[136:139], v[192:195], v[88:91]
    buffer_load_dwordx4 v[172:175], v236, s[48:51], s7 offen sc1
    v_mfma_f32_16x16x32_bf16 v[92:95], a[140:143], v[192:195], v[92:95]
    s_waitcnt vmcnt(8)
    v_mfma_f32_16x16x32_bf16 v[80:83], a[144:147], v[196:199], v[80:83]
    buffer_load_dwordx4 v[176:179], v236, s[48:51], s8 offen sc1
    buffer_load_dwordx4 v[180:183], v236, s[48:51], s9 offen sc1
    v_mfma_f32_16x16x32_bf16 v[84:87], a[148:151], v[196:199], v[84:87]
    s_waitcnt lgkmcnt(2)
    v_add_f32 v96, v96, v100
    v_mfma_f32_16x16x32_bf16 v[88:91], a[152:155], v[196:199], v[88:91]
    v_add_f32 v97, v97, v101
    v_add_f32 v98, v98, v102
    v_mfma_f32_16x16x32_bf16 v[92:95], a[156:159], v[196:199], v[92:95]
    v_add_f32 v99, v99, v103
    s_waitcnt vmcnt(9)
    v_mfma_f32_16x16x32_bf16 v[80:83], a[160:163], v[200:203], v[80:83]
    buffer_load_dwordx4 v[184:187], v236, s[48:51], s10 offen sc1
    s_waitcnt lgkmcnt(0)
    v_add_f32 v104, v104, v108
    v_mfma_f32_16x16x32_bf16 v[84:87], a[164:167], v[200:203], v[84:87]
    v_add_f32 v105, v105, v109
    v_mfma_f32_16x16x32_bf16 v[88:91], a[168:171], v[200:203], v[88:91]
    v_add_f32 v106, v106, v110
    v_mfma_f32_16x16x32_bf16 v[92:95], a[172:175], v[200:203], v[92:95]
    v_add_f32 v107, v107, v111
    s_waitcnt vmcnt(9)
    v_mfma_f32_16x16x32_bf16 v[80:83], a[176:179], v[204:207], v[80:83]
    buffer_load_dwordx4 v[188:191], v236, s[48:51], s11 offen sc1
    v_add_f32 v96, v96, v56
    v_mfma_f32_16x16x32_bf16 v[84:87], a[180:183], v[204:207], v[84:87]
    v_add_f32 v97, v97, v57
    v_mfma_f32_16x16x32_bf16 v[88:91], a[184:187], v[204:207], v[88:91]
    v_add_f32 v98, v98, v58
    v_mfma_f32_16x16x32_bf16 v[92:95], a[188:191], v[204:207], v[92:95]
    v_add_f32 v99, v99, v59
    s_waitcnt vmcnt(9)
    v_mfma_f32_16x16x32_bf16 v[80:83], a[192:195], v[208:211], v[80:83]
    buffer_load_dwordx4 v[192:195], v236, s[48:51], s12 offen sc1
    v_add_f32 v96, v96, v104
    v_mfma_f32_16x16x32_bf16 v[84:87], a[196:199], v[208:211], v[84:87]
    v_add_f32 v97, v97, v105
    v_mfma_f32_16x16x32_bf16 v[88:91], a[200:203], v[208:211], v[88:91]
    v_add_f32 v98, v98, v106
    v_mfma_f32_16x16x32_bf16 v[92:95], a[204:207], v[208:211], v[92:95]
    v_add_f32 v99, v99, v107
    s_waitcnt vmcnt(9)
    v_mfma_f32_16x16x32_bf16 v[80:83], a[208:211], v[212:215], v[80:83]
    buffer_load_dwordx4 v[196:199], v236, s[48:51], s13 offen sc1
    v_mfma_f32_16x16x32_bf16 v[84:87], a[212:215], v[212:215], v[84:87]
    v_cvt_pk_bf16_f32 v112, v96, v97
    v_mfma_f32_16x16x32_bf16 v[88:91], a[216:219], v[212:215], v[88:91]
    v_cvt_pk_bf16_f32 v113, v98, v99
    v_mfma_f32_16x16x32_bf16 v[92:95], a[220:223], v[212:215], v[92:95]
    s_waitcnt vmcnt(9)
    v_mfma_f32_16x16x32_bf16 v[64:67], a[0:3], v[160:163], 0
    buffer_load_dwordx4 v[200:203], v236, s[48:51], s14 offen sc1
    v_mfma_f32_16x16x32_bf16 v[68:71], a[4:7], v[160:163], 0
    v_mfma_f32_16x16x32_bf16 v[72:75], a[8:11], v[160:163], 0
    v_mfma_f32_16x16x32_bf16 v[76:79], a[12:15], v[160:163], 0
    s_waitcnt vmcnt(9)
    v_mfma_f32_16x16x32_bf16 v[64:67], a[16:19], v[164:167], v[64:67]
    buffer_load_dwordx4 v[204:207], v236, s[48:51], s15 offen sc1
    v_mfma_f32_16x16x32_bf16 v[68:71], a[20:23], v[164:167], v[68:71]
    v_mfma_f32_16x16x32_bf16 v[72:75], a[24:27], v[164:167], v[72:75]
    ds_write_b128 v240, v[80:83] offset:16384
    v_mfma_f32_16x16x32_bf16 v[76:79], a[28:31], v[164:167], v[76:79]
    s_waitcnt vmcnt(9)
    v_mfma_f32_16x16x32_bf16 v[64:67], a[32:35], v[168:171], v[64:67]
    buffer_load_dwordx4 v[208:211], v236, s[48:51], s16 offen sc1
    v_mfma_f32_16x16x32_bf16 v[68:71], a[36:39], v[168:171], v[68:71]
    v_mfma_f32_16x16x32_bf16 v[72:75], a[40:43], v[168:171], v[72:75]
    ds_write_b128 v241, v[84:87] offset:16384
    v_mfma_f32_16x16x32_bf16 v[76:79], a[44:47], v[168:171], v[76:79]
    s_waitcnt vmcnt(9)
    v_mfma_f32_16x16x32_bf16 v[64:67], a[48:51], v[172:175], v[64:67]
    buffer_load_dwordx4 v[212:215], v237, s[48:51], s17 offen sc1
    v_mfma_f32_16x16x32_bf16 v[68:71], a[52:55], v[172:175], v[68:71]
    v_mfma_f32_16x16x32_bf16 v[72:75], a[56:59], v[172:175], v[72:75]
    ds_write_b128 v240, v[88:91] offset:16512
    v_mfma_f32_16x16x32_bf16 v[76:79], a[60:63], v[172:175], v[76:79]
    s_waitcnt vmcnt(9)
    v_mfma_f32_16x16x32_bf16 v[64:67], a[64:67], v[176:179], v[64:67]
    v_add_u32 v236, s91, v246
    v_mfma_f32_16x16x32_bf16 v[68:71], a[68:71], v[176:179], v[68:71]
    v_add_u32 v237, s91, v247
    v_mfma_f32_16x16x32_bf16 v[72:75], a[72:75], v[176:179], v[72:75]
L_hpA41:
    s_cbranch_execz L_hpA_back0
    buffer_load_dwordx4 v[160:163], v236, s[48:51], s4 offen sc1
    v_mfma_f32_16x16x32_bf16 v[76:79], a[76:79], v[176:179], v[76:79]
    ds_write_b128 v241, v[92:95] offset:16512
    s_waitcnt vmcnt(9)
    v_mfma_f32_16x16x32_bf16 v[64:67], a[80:83], v[180:183], v[64:67]
    buffer_load_dwordx4 v[164:167], v236, s[48:51], s5 offen sc1
    v_mfma_f32_16x16x32_bf16 v[68:71], a[84:87], v[180:183], v[68:71]
    v_mfma_f32_16x16x32_bf16 v[72:75], a[88:91], v[180:183], v[72:75]
    v_mfma_f32_16x16x32_bf16 v[76:79], a[92:95], v[180:183], v[76:79]
    s_waitcnt vmcnt(9)
    v_mfma_f32_16x16x32_bf16 v[64:67], a[96:99], v[184:187], v[64:67]
    buffer_load_dwordx4 v[168:171], v236, s[48:51], s6 offen sc1
    v_mfma_f32_16x16x32_bf16 v[68:71], a[100:103], v[184:187], v[68:71]
    s_waitcnt lgkmcnt(0)
    s_barrier
    v_mfma_f32_16x16x32_bf16 v[72:75], a[104:107], v[184:187], v[72:75]
    ds_read_b128 v[96:99], v242 offset:16384
    v_mfma_f32_16x16x32_bf16 v[76:79], a[108:111], v[184:187], v[76:79]
    ds_read_b128 v[100:103], v242 offset:20480
    s_waitcnt vmcnt(9)
    v_mfma_f32_16x16x32_bf16 v[64:67], a[112:115], v[188:191], v[64:67]
    buffer_load_dwordx4 v[172:175], v236, s[48:51], s7 offen sc1
    v_mfma_f32_16x16x32_bf16 v[68:71], a[116:119], v[188:191], v[68:71]
    ds_read_b128 v[104:107], v242 offset:24576
    v_mfma_f32_16x16x32_bf16 v[72:75], a[120:123], v[188:191], v[72:75]
    ds_read_b128 v[108:111], v242 offset:28672
    v_mfma_f32_16x16x32_bf16 v[76:79], a[124:127], v[188:191], v[76:79]
    s_waitcnt vmcnt(9)
    v_mfma_f32_16x16x32_bf16 v[64:67], a[128:131], v[192:195], v[64:67]
    buffer_load_dwordx4 v[176:179], v236, s[48:51], s8 offen sc1
    v_mfma_f32_16x16x32_bf16 v[68:71], a[132:135], v[192:195], v[68:71]
    v_mfma_f32_16x16x32_bf16 v[72:75], a[136:139], v[192:195], v[72:75]
    v_mfma_f32_16x16x32_bf16 v[76:79], a[140:143], v[192:195], v[76:79]
    s_waitcnt vmcnt(9)
    v_mfma_f32_16x16x32_bf16 v[64:67], a[144:147], v[196:199], v[64:67]
    buffer_load_dwordx4 v[180:183], v236, s[48:51], s9 offen sc1
    s_waitcnt lgkmcnt(2)
    v_add_f32 v96, v96, v100
    v_mfma_f32_16x16x32_bf16 v[68:71], a[148:151], v[196:199], v[68:71]
    v_add_f32 v97, v97, v101
    v_mfma_f32_16x16x32_bf16 v[72:75], a[152:155], v[196:199], v[72:75]
    v_add_f32 v98, v98, v102
    v_mfma_f32_16x16x32_bf16 v[76:79], a[156:159], v[196:199], v[76:79]
    v_add_f32 v99, v99, v103
    s_waitcnt vmcnt(9)
    v_mfma_f32_16x16x32_bf16 v[64:67], a[160:163], v[200:203], v[64:67]
    buffer_load_dwordx4 v[184:187], v236, s[48:51], s10 offen sc1
    s_waitcnt lgkmcnt(0)
    v_add_f32 v104, v104, v108
    v_mfma_f32_16x16x32_bf16 v[68:71], a[164:167], v[200:203], v[68:71]
    v_add_f32 v105, v105, v109
    v_mfma_f32_16x16x32_bf16 v[72:75], a[168:171], v[200:203], v[72:75]
    v_add_f32 v106, v106, v110
    v_mfma_f32_16x16x32_bf16 v[76:79], a[172:175], v[200:203], v[76:79]
    v_add_f32 v107, v107, v111
    s_waitcnt vmcnt(9)
    v_mfma_f32_16x16x32_bf16 v[64:67], a[176:179], v[204:207], v[64:67]
    buffer_load_dwordx4 v[188:191], v236, s[48:51], s11 offen sc1
    v_add_f32 v96, v96, v56
    v_mfma_f32_16x16x32_bf16 v[68:71], a[180:183], v[204:207], v[68:71]
    v_add_f32 v97, v97, v57
    v_mfma_f32_16x16x32_bf16 v[72:75], a[184:187], v[204:207], v[72:75]
    v_add_f32 v98, v98, v58
    v_mfma_f32_16x16x32_bf16 v[76:79], a[188:191], v[204:207], v[76:79]
    v_add_f32 v99, v99, v59
    s_waitcnt vmcnt(9)
    v_mfma_f32_16x16x32_bf16 v[64:67], a[192:195], v[208:211], v[64:67]
    buffer_load_dwordx4 v[192:195], v236, s[48:51], s12 offen sc1
    v_add_f32 v96, v96, v104
    v_mfma_f32_16x16x32_bf16 v[68:71], a[196:199], v[208:211], v[68:71]
    v_add_f32 v97, v97, v105
    v_mfma_f32_16x16x32_bf16 v[72:75], a[200:203], v[208:211], v[72:75]
    v_add_f32 v98, v98, v106
    v_mfma_f32_16x16x32_bf16 v[76:79], a[204:207], v[208:211], v[76:79]
    v_add_f32 v99, v99, v107
    s_waitcnt vmcnt(9)
    v_mfma_f32_16x16x32_bf16 v[64:67], a[208:211], v[212:215], v[64:67]
    buffer_load_dwordx4 v[196:199], v236, s[48:51], s13 offen sc1
    v_mfma_f32_16x16x32_bf16 v[68:71], a[212:215], v[212:215], v[68:71]
    v_cvt_pk_bf16_f32 v114, v96, v97
    v_mfma_f32_16x16x32_bf16 v[72:75], a[216:219], v[212:215], v[72:75]
    v_cvt_pk_bf16_f32 v115, v98, v99
    v_mfma_f32_16x16x32_bf16 v[76:79], a[220:223], v[212:215], v[76:79]
    s_waitcnt vmcnt(9)
    v_mfma_f32_16x16x32_bf16 v[80:83], a[0:3], v[160:163], 0
    buffer_load_dwordx4 v[200:203], v236, s[48:51], s14 offen sc1
    v_mfma_f32_16x16x32_bf16 v[84:87], a[4:7], v[160:163], 0
    v_mfma_f32_16x16x32_bf16 v[88:91], a[8:11], v[160:163], 0
    v_mfma_f32_16x16x32_bf16 v[92:95], a[12:15], v[160:163], 0
    s_waitcnt vmcnt(9)
    v_mfma_f32_16x16x32_bf16 v[80:83], a[16:19], v[164:167], v[80:83]
    buffer_load_dwordx4 v[204:207], v236, s[48:51], s15 offen sc1
    v_mfma_f32_16x16x32_bf16 v[84:87], a[20:23], v[164:167], v[84:87]
    v_mfma_f32_16x16x32_bf16 v[88:91], a[24:27], v[164:167], v[88:91]
    ds_write_b128 v240, v[64:67] offset:0
    v_mfma_f32_16x16x32_bf16 v[92:95], a[28:31], v[164:167], v[92:95]
    s_waitcnt vmcnt(9)
    v_mfma_f32_16x16x32_bf16 v[80:83], a[32:35], v[168:171], v[80:83]
    buffer_load_dwordx4 v[208:211], v236, s[48:51], s16 offen sc1
    v_mfma_f32_16x16x32_bf16 v[84:87], a[36:39], v[168:171], v[84:87]
    v_mfma_f32_16x16x32_bf16 v[88:91], a[40:43], v[168:171], v[88:91]
    ds_write_b128 v241, v[68:71] offset:0
    v_mfma_f32_16x16x32_bf16 v[92:95], a[44:47], v[168:171], v[92:95]
    s_waitcnt vmcnt(9)
    v_mfma_f32_16x16x32_bf16 v[80:83], a[48:51], v[172:175], v[80:83]
    buffer_load_dwordx4 v[212:215], v237, s[48:51], s17 offen sc1
    v_mfma_f32_16x16x32_bf16 v[84:87], a[52:55], v[172:175], v[84:87]
    v_mfma_f32_16x16x32_bf16 v[88:91], a[56:59], v[172:175], v[88:91]
    ds_write_b128 v240, v[72:75] offset:128
    v_mfma_f32_16x16x32_bf16 v[92:95], a[60:63], v[172:175], v[92:95]
    s_waitcnt vmcnt(9)
    v_mfma_f32_16x16x32_bf16 v[80:83], a[64:67], v[176:179], v[80:83]
    v_add_u32 v236, s92, v246
    v_mfma_f32_16x16x32_bf16 v[84:87], a[68:71], v[176:179], v[84:87]
    v_add_u32 v237, s92, v247
    v_mfma_f32_16x16x32_bf16 v[88:91], a[72:75], v[176:179], v[88:91]
    buffer_load_dwordx4 v[160:163], v236, s[48:51], s4 offen sc1
    v_mfma_f32_16x16x32_bf16 v[92:95], a[76:79], v[176:179], v[92:95]
    ds_write_b128 v241, v[76:79] offset:128
    s_waitcnt vmcnt(9)
    v_mfma_f32_16x16x32_bf16 v[80:83], a[80:83], v[180:183], v[80:83]
    buffer_load_dwordx4 v[164:167], v236, s[48:51], s5 offen sc1
    v_mfma_f32_16x16x32_bf16 v[84:87], a[84:87], v[180:183], v[84:87]
    v_mfma_f32_16x16x32_bf16 v[88:91], a[88:91], v[180:183], v[88:91]
    v_mfma_f32_16x16x32_bf16 v[92:95], a[92:95], v[180:183], v[92:95]
    s_waitcnt vmcnt(9)
    v_mfma_f32_16x16x32_bf16 v[80:83], a[96:99], v[184:187], v[80:83]
    buffer_load_dwordx4 v[168:171], v236, s[48:51], s6 offen sc1
    v_mfma_f32_16x16x32_bf16 v[84:87], a[100:103], v[184:187], v[84:87]
    s_waitcnt lgkmcnt(0)
    s_barrier
    v_mfma_f32_16x16x32_bf16 v[88:91], a[104:107], v[184:187], v[88:91]
    ds_read_b128 v[96:99], v242 offset:0
    v_mfma_f32_16x16x32_bf16 v[92:95], a[108:111], v[184:187], v[92:95]
    ds_read_b128 v[100:103], v242 offset:4096
    s_waitcnt vmcnt(9)
    v_mfma_f32_16x16x32_bf16 v[80:83], a[112:115], v[188:191], v[80:83]
    buffer_load_dwordx4 v[172:175], v236, s[48:51], s7 offen sc1
    v_mfma_f32_16x16x32_bf16 v[84:87], a[116:119], v[188:191], v[84:87]
    ds_read_b128 v[104:107], v242 offset:8192
    v_mfma_f32_16x16x32_bf16 v[88:91], a[120:123], v[188:191], v[88:91]
    ds_read_b128 v[108:111], v242 offset:12288
    v_mfma_f32_16x16x32_bf16 v[92:95], a[124:127], v[188:191], v[92:95]
    s_waitcnt vmcnt(9)
    v_mfma_f32_16x16x32_bf16 v[80:83], a[128:131], v[192:195], v[80:83]
    buffer_load_dwordx4 v[176:179], v236, s[48:51], s8 offen sc1
    v_mfma_f32_16x16x32_bf16 v[84:87], a[132:135], v[192:195], v[84:87]
    v_mfma_f32_16x16x32_bf16 v[88:91], a[136:139], v[192:195], v[88:91]
L_pg3:
    s_cbranch_execz L_pg_back
L_hpA42:
    s_cbranch_execz L_hpA_back0
    v_mfma_f32_16x16x32_bf16 v[92:95], a[140:143], v[192:195], v[92:95]
    s_waitcnt vmcnt(9)
    v_mfma_f32_16x16x32_bf16 v[80:83], a[144:147], v[196:199], v[80:83]
    buffer_load_dwordx4 v[180:183], v236, s[48:51], s9 offen sc1
    s_waitcnt lgkmcnt(2)
    v_add_f32 v96, v96, v100
    v_mfma_f32_16x16x32_bf16 v[84:87], a[148:151], v[196:199], v[84:87]
    v_add_f32 v97, v97, v101
    v_mfma_f32_16x16x32_bf16 v[88:91], a[152:155], v[196:199], v[88:91]
    v_add_f32 v98, v98, v102
    v_mfma_f32_16x16x32_bf16 v[92:95], a[156:159], v[196:199], v[92:95]
    v_add_f32 v99, v99, v103
    s_waitcnt vmcnt(9)
    v_mfma_f32_16x16x32_bf16 v[80:83], a[160:163], v[200:203], v[80:83]
    buffer_load_dwordx4 v[184:187], v236, s[48:51], s10 offen sc1
    s_waitcnt lgkmcnt(0)
    v_add_f32 v104, v104, v108
    v_mfma_f32_16x16x32_bf16 v[84:87], a[164:167], v[200:203], v[84:87]
    v_add_f32 v105, v105, v109
    v_mfma_f32_16x16x32_bf16 v[88:91], a[168:171], v[200:203], v[88:91]
    v_add_f32 v106, v106, v110
    v_mfma_f32_16x16x32_bf16 v[92:95], a[172:175], v[200:203], v[92:95]
    v_add_f32 v107, v107, v111
    s_waitcnt vmcnt(9)
    v_mfma_f32_16x16x32_bf16 v[80:83], a[176:179], v[204:207], v[80:83]
    buffer_load_dwordx4 v[188:191], v236, s[48:51], s11 offen sc1
    v_add_f32 v96, v96, v56
    v_mfma_f32_16x16x32_bf16 v[84:87], a[180:183], v[204:207], v[84:87]
    v_add_f32 v97, v97, v57
    v_mfma_f32_16x16x32_bf16 v[88:91], a[184:187], v[204:207], v[88:91]
    v_add_f32 v98, v98, v58
    v_mfma_f32_16x16x32_bf16 v[92:95], a[188:191], v[204:207], v[92:95]
    v_add_f32 v99, v99, v59
    s_waitcnt vmcnt(9)
    v_mfma_f32_16x16x32_bf16 v[80:83], a[192:195], v[208:211], v[80:83]
    buffer_load_dwordx4 v[192:195], v236, s[48:51], s12 offen sc1
    v_add_f32 v96, v96, v104
    v_mfma_f32_16x16x32_bf16 v[84:87], a[196:199], v[208:211], v[84:87]
    v_add_f32 v97, v97, v105
    v_mfma_f32_16x16x32_bf16 v[88:91], a[200:203], v[208:211], v[88:91]
    v_add_f32 v98, v98, v106
    v_mfma_f32_16x16x32_bf16 v[92:95], a[204:207], v[208:211], v[92:95]
    v_add_f32 v99, v99, v107
    s_waitcnt vmcnt(9)
    v_mfma_f32_16x16x32_bf16 v[80:83], a[208:211], v[212:215], v[80:83]
    buffer_load_dwordx4 v[196:199], v236, s[48:51], s13 offen sc1
    v_mfma_f32_16x16x32_bf16 v[84:87], a[212:215], v[212:215], v[84:87]
    v_cvt_pk_bf16_f32 v116, v96, v97
    v_mfma_f32_16x16x32_bf16 v[88:91], a[216:219], v[212:215], v[88:91]
    v_cvt_pk_bf16_f32 v117, v98, v99
    v_mfma_f32_16x16x32_bf16 v[92:95], a[220:223], v[212:215], v[92:95]
    s_waitcnt vmcnt(9)
    v_mfma_f32_16x16x32_bf16 v[64:67], a[0:3], v[160:163], 0
    buffer_load_dwordx4 v[200:203], v236, s[48:51], s14 offen sc1
    v_mfma_f32_16x16x32_bf16 v[68:71], a[4:7], v[160:163], 0
    v_mfma_f32_16x16x32_bf16 v[72:75], a[8:11], v[160:163], 0
    v_mfma_f32_16x16x32_bf16 v[76:79], a[12:15], v[160:163], 0
    s_waitcnt vmcnt(9)
    v_mfma_f32_16x16x32_bf16 v[64:67], a[16:19], v[164:167], v[64:67]
    buffer_load_dwordx4 v[204:207], v236, s[48:51], s15 offen sc1
    v_mfma_f32_16x16x32_bf16 v[68:71], a[20:23], v[164:167], v[68:71]
    v_mfma_f32_16x16x32_bf16 v[72:75], a[24:27], v[164:167], v[72:75]
    ds_write_b128 v240, v[80:83] offset:16384
    v_mfma_f32_16x16x32_bf16 v[76:79], a[28:31], v[164:167], v[76:79]
    s_waitcnt vmcnt(9)
    v_mfma_f32_16x16x32_bf16 v[64:67], a[32:35], v[168:171], v[64:67]
    buffer_load_dwordx4 v[208:211], v236, s[48:51], s16 offen sc1
    v_mfma_f32_16x16x32_bf16 v[68:71], a[36:39], v[168:171], v[68:71]
    v_mfma_f32_16x16x32_bf16 v[72:75], a[40:43], v[168:171], v[72:75]
    ds_write_b128 v241, v[84:87] offset:16384
    v_mfma_f32_16x16x32_bf16 v[76:79], a[44:47], v[168:171], v[76:79]
    s_waitcnt vmcnt(9)
    v_mfma_f32_16x16x32_bf16 v[64:67], a[48:51], v[172:175], v[64:67]
    buffer_load_dwordx4 v[212:215], v237, s[48:51], s17 offen sc1
    v_mfma_f32_16x16x32_bf16 v[68:71], a[52:55], v[172:175], v[68:71]
    v_mfma_f32_16x16x32_bf16 v[72:75], a[56:59], v[172:175], v[72:75]
    ds_write_b128 v240, v[88:91] offset:16512
    v_mfma_f32_16x16x32_bf16 v[76:79], a[60:63], v[172:175], v[76:79]
    s_waitcnt vmcnt(9)
    v_mfma_f32_16x16x32_bf16 v[64:67], a[64:67], v[176:179], v[64:67]
    ds_write_b128 v241, v[92:95] offset:16512
    v_mfma_f32_16x16x32_bf16 v[68:71], a[68:71], v[176:179], v[68:71]
    v_mfma_f32_16x16x32_bf16 v[72:75], a[72:75], v[176:179], v[72:75]
    buffer_store_dwordx2 v[112:113], v248, s[40:43], s94 offen sc1
    v_mfma_f32_16x16x32_bf16 v[76:79], a[76:79], v[176:179], v[76:79]
    s_waitcnt vmcnt(9)
    v_mfma_f32_16x16x32_bf16 v[64:67], a[80:83], v[180:183], v[64:67]
    buffer_store_dwordx2 v[114:115], v248, s[40:43], s95 offen sc1
    v_mfma_f32_16x16x32_bf16 v[68:71], a[84:87], v[180:183], v[68:71]
    v_mfma_f32_16x16x32_bf16 v[72:75], a[88:91], v[180:183], v[72:75]
    v_mfma_f32_16x16x32_bf16 v[76:79], a[92:95], v[180:183], v[76:79]
    s_waitcnt vmcnt(9)
    v_mfma_f32_16x16x32_bf16 v[64:67], a[96:99], v[184:187], v[64:67]
    s_waitcnt lgkmcnt(0)
    s_barrier
    v_mfma_f32_16x16x32_bf16 v[68:71], a[100:103], v[184:187], v[68:71]
    ds_read_b128 v[96:99], v242 offset:16384
    v_mfma_f32_16x16x32_bf16 v[72:75], a[104:107], v[184:187], v[72:75]
    ds_read_b128 v[100:103], v242 offset:20480
    v_mfma_f32_16x16x32_bf16 v[76:79], a[108:111], v[184:187], v[76:79]
    buffer_store_dwordx2 v[116:117], v248, s[40:43], s96 offen sc1
    s_waitcnt vmcnt(9)
    v_mfma_f32_16x16x32_bf16 v[64:67], a[112:115], v[188:191], v[64:67]
    ds_read_b128 v[104:107], v242 offset:24576
    v_mfma_f32_16x16x32_bf16 v[68:71], a[116:119], v[188:191], v[68:71]
    v_mfma_f32_16x16x32_bf16 v[72:75], a[120:123], v[188:191], v[72:75]
    ds_read_b128 v[108:111], v242 offset:28672
    v_mfma_f32_16x16x32_bf16 v[76:79], a[124:127], v[188:191], v[76:79]
    s_waitcnt vmcnt(8)
    v_mfma_f32_16x16x32_bf16 v[64:67], a[128:131], v[192:195], v[64:67]
    v_mfma_f32_16x16x32_bf16 v[68:71], a[132:135], v[192:195], v[68:71]
    v_mfma_f32_16x16x32_bf16 v[72:75], a[136:139], v[192:195], v[72:75]
    v_mfma_f32_16x16x32_bf16 v[76:79], a[140:143], v[192:195], v[76:79]
    s_waitcnt vmcnt(7)
    v_mfma_f32_16x16x32_bf16 v[64:67], a[144:147], v[196:199], v[64:67]
    s_waitcnt lgkmcnt(2)
    v_add_f32 v96, v96, v100
    v_mfma_f32_16x16x32_bf16 v[68:71], a[148:151], v[196:199], v[68:71]
    v_add_f32 v97, v97, v101
    v_mfma_f32_16x16x32_bf16 v[72:75], a[152:155], v[196:199], v[72:75]
    v_add_f32 v98, v98, v102
    v_mfma_f32_16x16x32_bf16 v[76:79], a[156:159], v[196:199], v[76:79]
    v_add_f32 v99, v99, v103
    s_waitcnt vmcnt(6)
    v_mfma_f32_16x16x32_bf16 v[64:67], a[160:163], v[200:203], v[64:67]
    s_waitcnt lgkmcnt(0)
    v_add_f32 v104, v104, v108
    v_mfma_f32_16x16x32_bf16 v[68:71], a[164:167], v[200:203], v[68:71]
    v_add_f32 v105, v105, v109
    v_mfma_f32_16x16x32_bf16 v[72:75], a[168:171], v[200:203], v[72:75]
    v_add_f32 v106, v106, v110
    v_mfma_f32_16x16x32_bf16 v[76:79], a[172:175], v[200:203], v[76:79]
    v_add_f32 v107, v107, v111
    s_waitcnt vmcnt(5)
    v_mfma_f32_16x16x32_bf16 v[64:67], a[176:179], v[204:207], v[64:67]
    v_add_f32 v96, v96, v56
    v_mfma_f32_16x16x32_bf16 v[68:71], a[180:183], v[204:207], v[68:71]
    v_add_f32 v97, v97, v57
    v_mfma_f32_16x16x32_bf16 v[72:75], a[184:187], v[204:207], v[72:75]
    v_add_f32 v98, v98, v58
    v_mfma_f32_16x16x32_bf16 v[76:79], a[188:191], v[204:207], v[76:79]
    v_add_f32 v99, v99, v59
    s_waitcnt vmcnt(4)
    v_mfma_f32_16x16x32_bf16 v[64:67], a[192:195], v[208:211], v[64:67]
    v_add_f32 v96, v96, v104
    v_mfma_f32_16x16x32_bf16 v[68:71], a[196:199], v[208:211], v[68:71]
    v_add_f32 v97, v97, v105
    v_mfma_f32_16x16x32_bf16 v[72:75], a[200:203], v[208:211], v[72:75]
    v_add_f32 v98, v98, v106
    v_mfma_f32_16x16x32_bf16 v[76:79], a[204:207], v[208:211], v[76:79]
    v_add_f32 v99, v99, v107
    s_waitcnt vmcnt(3)
    v_mfma_f32_16x16x32_bf16 v[64:67], a[208:211], v[212:215], v[64:67]
    v_cvt_pk_bf16_f32 v118, v96, v97
    v_mfma_f32_16x16x32_bf16 v[68:71], a[212:215], v[212:215], v[68:71]
    v_cvt_pk_bf16_f32 v119, v98, v99
L_hpA43:
    s_cbranch_execz L_hpA_back0
    v_mfma_f32_16x16x32_bf16 v[72:75], a[216:219], v[212:215], v[72:75]
    buffer_store_dwordx2 v[118:119], v248, s[40:43], s97 offen sc1
    v_mfma_f32_16x16x32_bf16 v[76:79], a[220:223], v[212:215], v[76:79]
    s_nop 1
    ds_write_b128 v240, v[64:67] offset:0
    s_nop 0
    ds_write_b128 v241, v[68:71] offset:0
    s_nop 0
    ds_write_b128 v240, v[72:75] offset:128
    s_nop 0
    ds_write_b128 v241, v[76:79] offset:128
    s_waitcnt lgkmcnt(0)
    s_barrier
    ds_read_b128 v[96:99], v242 offset:0
    ds_read_b128 v[100:103], v242 offset:4096
    ds_read_b128 v[104:107], v242 offset:8192
    ds_read_b128 v[108:111], v242 offset:12288
    s_waitcnt lgkmcnt(2)
    v_add_f32 v96, v96, v100
L_hpA44:
    s_cbranch_execz L_hpA_back0
    v_add_f32 v97, v97, v101
    v_add_f32 v98, v98, v102
    v_add_f32 v99, v99, v103
    s_waitcnt lgkmcnt(0)
    v_add_f32 v104, v104, v108
    v_add_f32 v105, v105, v109
    v_add_f32 v106, v106, v110
    v_add_f32 v107, v107, v111
    v_add_f32 v96, v96, v56
    v_add_f32 v97, v97, v57
    v_add_f32 v98, v98, v58
    v_add_f32 v99, v99, v59
    v_add_f32 v96, v96, v104
    v_add_f32 v97, v97, v105
    v_add_f32 v98, v98, v106
    v_add_f32 v99, v99, v107
    v_cvt_pk_bf16_f32 v120, v96, v97
    v_cvt_pk_bf16_f32 v121, v98, v99
    buffer_store_dwordx2 v[120:121], v248, s[40:43], s98 offen sc1
    s_endpgm
L_idle:
    s_load_dwordx2 s[32:33], s[0:1], 24
    s_load_dwordx2 s[48:49], s[0:1], 56
    s_load_dwordx2 s[44:45], s[0:1], 48
    s_load_dwordx2 s[36:37], s[0:1], 32
    s_load_dwordx2 s[40:41], s[0:1], 40
    s_mov_b32 s34, 2211840
    s_mov_b32 s35, 0x20000
    s_mov_b32 s26, 2211840
    s_mov_b32 s27, 0x20000
    v_lshrrev_b32 v2, 6, v0
    v_and_b32 v1, 63, v0
    v_readfirstlane_b32 s56, v2
    s_and_b32 s73, s2, 7
    s_lshr_b32 s72, s2, 3
    s_lshl_b32 s57, s56, 12
    s_waitcnt lgkmcnt(0)
    s_sub_u32 s62, s72, 28
    s_lshl2_add_u32 s62, s62, s56
    s_lshr_b32 s63, s62, 1
    s_mul_i32 s64, s63, 6
    s_and_b32 s65, s64, 2
    s_lshr_b32 s64, s64, 2
    s_sub_u32 s64, s64, s65
    s_and_b32 s62, s62, 1
    s_mul_i32 s62, s62, 5
    s_add_u32 s64, s64, s62
    s_add_u32 s64, s64, 4
    s_sub_u32 s65, s64, 10
    s_min_u32 s64, s64, s65
    s_mul_i32 s64, s64, 221184
    s_and_b32 s65, s73, 1
    s_mul_i32 s65, s65, 7
    s_add_u32 s65, s65, s63
    s_cmp_lt_u32 s63, 7
    s_cselect_b32 s64, s64, 1073741824
    s_lshl_b32 s62, s65, 8
    s_add_u32 s64, s64, s62
    s_cmp_lt_u32 s65, 13
    s_cselect_b32 s62, 128, 0
    v_mul_u32_u24 v2, 3456, v1
    v_add_u32 v2, s64, v2
    v_add_u32 v3, s62, v2
    buffer_load_dword v253, v2, s[24:27], 0 offen
    buffer_load_dword v254, v3, s[24:27], 0 offen
    s_lshr_b32 s63, s73, 1
    s_lshl2_add_u32 s75, s63, s72
    s_add_u32 s75, s75, 82
    s_mul_i32 s66, s75, 205
    s_lshr_b32 s66, s66, 10
    s_mul_i32 s62, s66, 5
    s_sub_u32 s63, s75, s62
    s_and_b32 s67, s73, 1
    s_mul_i32 s67, s67, 5
    s_add_u32 s67, s67, s63
    s_mul_i32 s63, s63, 10
    s_mul_i32 s62, s66, 10
    s_add_u32 s62, s62, s63
    s_lshr_b32 s62, s62, 2
    s_mul_i32 s63, s62, 1261
    s_lshr_b32 s63, s63, 14
    s_mul_i32 s63, s63, 13
    s_sub_u32 s62, s62, s63
    s_mul_i32 s70, s62, 163840
    s_lshl_b32 s4, s62, 12
    s_mul_i32 s62, s56, 40960
    s_lshl_b32 s63, s67, 7
    s_add_u32 s62, s62, s63
    v_lshrrev_b32 v2, 3, v1
    v_and_b32 v3, 7, v1
    v_and_b32 v4, 6, v2
    v_xor_b32 v3, v3, v4
    v_lshlrev_b32 v3, 4, v3
    v_mul_u32_u24 v4, 1280, v2
    v_add3_u32 v18, v4, v3, s62
    v_add_u32 v19, 9216, v18
    v_add_u32 v20, 18432, v18
    v_add_u32 v21, 27648, v18
    s_mov_b32 s50, 7077888
    s_mov_b32 s51, 0x20000
    s_mov_b32 s46, 256
    s_mov_b32 s47, 0x20000
    s_mov_b32 s38, 1280
    s_mov_b32 s39, 0x20000
    s_mov_b32 s42, 2621440
    s_mov_b32 s43, 0x20000
    s_add_u32 s52, s48, 8388608
    s_addc_u32 s53, s49, 0
    s_mov_b32 s54, 16384
    s_mov_b32 s55, 0x20000
    s_cmp_lg_u32 s56, 0
    s_cbranch_scc1 L_noclear
    s_sub_u32 s62, s2, 224
    s_lshl_b32 s62, s62, 9
    v_lshl_add_u32 v2, v1, 3, s62
    v_mov_b32 v4, 0
    v_mov_b32 v5, 0
    v_mov_b32 v6, 1
    v_min_u32 v7, 1, v1
    v_lshlrev_b32 v7, 30, v7
    buffer_store_dwordx2 v[4:5], v2, s[52:55], 0 offen sc1
    s_waitcnt vmcnt(0)
    buffer_atomic_add v6, v7, s[44:47], 0 offen sc1
L_noclear:
    s_cmp_ge_u32 s75, 125
    s_cbranch_scc1 L_fin
    s_add_u32 m0, s57, 0
    s_nop 0
    buffer_load_dwordx4 v18, s[32:35], s70 offen offset:0 lds
    buffer_load_dwordx4 v19, s[32:35], s70 offen offset:1024 lds
    buffer_load_dwordx4 v20, s[32:35], s70 offen offset:2048 lds
    buffer_load_dwordx4 v21, s[32:35], s70 offen offset:3072 lds
    s_add_u32 s70, s70, 163840
    s_cmp_eq_u32 s70, 2129920
    s_cselect_b32 s70, 0, s70
    s_add_u32 m0, s57, 16384
    s_nop 0
    buffer_load_dwordx4 v18, s[32:35], s70 offen offset:0 lds
    buffer_load_dwordx4 v19, s[32:35], s70 offen offset:1024 lds
    buffer_load_dwordx4 v20, s[32:35], s70 offen offset:2048 lds
    buffer_load_dwordx4 v21, s[32:35], s70 offen offset:3072 lds
    s_add_u32 s70, s70, 163840
    s_cmp_eq_u32 s70, 2129920
    s_cselect_b32 s70, 0, s70
    s_add_u32 m0, s57, 32768
    s_nop 0
    buffer_load_dwordx4 v18, s[32:35], s70 offen offset:0 lds
    buffer_load_dwordx4 v19, s[32:35], s70 offen offset:1024 lds
    buffer_load_dwordx4 v20, s[32:35], s70 offen offset:2048 lds
    buffer_load_dwordx4 v21, s[32:35], s70 offen offset:3072 lds
    s_add_u32 s70, s70, 163840
    s_cmp_eq_u32 s70, 2129920
    s_cselect_b32 s70, 0, s70
    s_add_u32 m0, s57, 49152
    s_nop 0
    buffer_load_dwordx4 v18, s[32:35], s70 offen offset:0 lds
    buffer_load_dwordx4 v19, s[32:35], s70 offen offset:1024 lds
    buffer_load_dwordx4 v20, s[32:35], s70 offen offset:2048 lds
    buffer_load_dwordx4 v21, s[32:35], s70 offen offset:3072 lds
    s_add_u32 s70, s70, 163840
    s_cmp_eq_u32 s70, 2129920
    s_cselect_b32 s70, 0, s70
    s_add_u32 m0, s57, 65536
    s_nop 0
    buffer_load_dwordx4 v18, s[32:35], s70 offen offset:0 lds
    buffer_load_dwordx4 v19, s[32:35], s70 offen offset:1024 lds
    buffer_load_dwordx4 v20, s[32:35], s70 offen offset:2048 lds
    buffer_load_dwordx4 v21, s[32:35], s70 offen offset:3072 lds
    s_add_u32 s70, s70, 163840
    s_cmp_eq_u32 s70, 2129920
    s_cselect_b32 s70, 0, s70
    s_add_u32 m0, s57, 81920
    s_nop 0
    buffer_load_dwordx4 v18, s[32:35], s70 offen offset:0 lds
    buffer_load_dwordx4 v19, s[32:35], s70 offen offset:1024 lds
    buffer_load_dwordx4 v20, s[32:35], s70 offen offset:2048 lds
    buffer_load_dwordx4 v21, s[32:35], s70 offen offset:3072 lds
    s_add_u32 s70, s70, 163840
    s_cmp_eq_u32 s70, 2129920
    s_cselect_b32 s70, 0, s70
    s_add_u32 m0, s57, 98304
    s_nop 0
    buffer_load_dwordx4 v18, s[32:35], s70 offen offset:0 lds
    buffer_load_dwordx4 v19, s[32:35], s70 offen offset:1024 lds
    buffer_load_dwordx4 v20, s[32:35], s70 offen offset:2048 lds
    buffer_load_dwordx4 v21, s[32:35], s70 offen offset:3072 lds
    s_add_u32 s70, s70, 163840
    s_cmp_eq_u32 s70, 2129920
    s_cselect_b32 s70, 0, s70
    s_add_u32 m0, s57, 114688
    s_nop 0
    buffer_load_dwordx4 v18, s[32:35], s70 offen offset:0 lds
    buffer_load_dwordx4 v19, s[32:35], s70 offen offset:1024 lds
    buffer_load_dwordx4 v20, s[32:35], s70 offen offset:2048 lds
    buffer_load_dwordx4 v21, s[32:35], s70 offen offset:3072 lds
    s_add_u32 s70, s70, 163840
    s_cmp_eq_u32 s70, 2129920
    s_cselect_b32 s70, 0, s70
    s_add_u32 m0, s57, 131072
    s_nop 0
    buffer_load_dwordx4 v18, s[32:35], s70 offen offset:0 lds
    buffer_load_dwordx4 v19, s[32:35], s70 offen offset:1024 lds
    buffer_load_dwordx4 v20, s[32:35], s70 offen offset:2048 lds
    buffer_load_dwordx4 v21, s[32:35], s70 offen offset:3072 lds
    s_add_u32 s70, s70, 163840
    s_cmp_eq_u32 s70, 2129920
    s_cselect_b32 s70, 0, s70
    s_add_u32 m0, s57, 147456
    s_nop 0
    buffer_load_dwordx4 v18, s[32:35], s70 offen offset:0 lds
    buffer_load_dwordx4 v19, s[32:35], s70 offen offset:1024 lds
    buffer_load_dwordx4 v20, s[32:35], s70 offen offset:2048 lds
    buffer_load_dwordx4 v21, s[32:35], s70 offen offset:3072 lds
    s_add_u32 s70, s70, 163840
    s_cmp_eq_u32 s70, 2129920
    s_cselect_b32 s70, 0, s70
    s_lshl2_add_u32 s68, s66, 28
    s_lshl_b32 s62, s66, 9
    s_lshr_b32 s63, s68, 2
    s_lshl_b32 s63, s63, 9
    s_cmp_eq_u32 s56, 0
    s_cselect_b32 s62, s62, 1073741824
    s_cselect_b32 s63, s63, 1073741824
    v_mov_b32 v243, s62
    v_mov_b32 v249, s62
    v_writelane_b32 v243, s63, 1
    s_cmp_lt_u32 s56, 2
    s_cselect_b32 s71, 0, 1073741824
    v_lshrrev_b32 v3, 2, v1
    v_lshlrev_b32 v3, 7, v3
    v_and_b32 v4, 3, v1
    v_lshl_add_u32 v3, v4, 3, v3
    v_bfe_u32 v2, v1, 3, 2
    v_lshl_add_u32 v3, v2, 5, v3
    v_add_u32 v224, s57, v3
    v_xor_b32 v225, 32, v224
    v_xor_b32 v226, 64, v224
    v_xor_b32 v227, 96, v224
    v_add_u32 v228, 65536, v224
    v_add_u32 v229, 65536, v225
    v_add_u32 v230, 65536, v226
    v_add_u32 v231, 65536, v227
    v_add_u32 v232, 131072, v224
    v_add_u32 v233, 131072, v225
    v_add_u32 v234, 131072, v226
    v_add_u32 v235, 131072, v227
    s_lshl_b32 s62, s56, 10
    v_lshl_add_u32 v246, v1, 4, s62
    v_add_u32 v247, s71, v246
    v_and_b32 v2, 15, v1
    v_lshrrev_b32 v3, 4, v1
    s_lshl_b32 s62, s67, 7
    v_lshl_add_u32 v239, v2, 3, s62
    s_mul_i32 s63, s56, 5120
    v_mul_u32_u24 v4, 1280, v3
    v_add3_u32 v248, v4, v239, s63
    buffer_load_dwordx2 v[60:61], v239, s[36:39], 0 offen
    s_add_u32 s62, s57, 65536
    v_and_b32 v4, 7, v2
    v_xor_b32 v4, v4, v3
    v_lshlrev_b32 v4, 4, v4
    v_lshl_add_u32 v4, v2, 8, v4
    v_add_u32 v240, s62, v4
    v_xor_b32 v241, 64, v240
    s_lshl_b32 s62, s56, 2
    v_add_u32 v4, s62, v3
    v_and_b32 v5, 7, v4
    v_xor_b32 v5, v5, v2
    v_lshlrev_b32 v5, 4, v5
    v_lshl_add_u32 v5, v4, 8, v5
    v_add_u32 v242, 65536, v5
    s_add_u32 s5, s4, 4096
    s_cmp_eq_u32 s5, 53248
    s_cselect_b32 s5, 0, s5
    s_add_u32 s6, s5, 4096
    s_cmp_eq_u32 s6, 53248
    s_cselect_b32 s6, 0, s6
    s_add_u32 s7, s6, 4096
    s_cmp_eq_u32 s7, 53248
    s_cselect_b32 s7, 0, s7
    s_add_u32 s8, s7, 4096
    s_cmp_eq_u32 s8, 53248
    s_cselect_b32 s8, 0, s8
    s_add_u32 s9, s8, 4096
    s_cmp_eq_u32 s9, 53248
    s_cselect_b32 s9, 0, s9
    s_add_u32 s10, s9, 4096
    s_cmp_eq_u32 s10, 53248
    s_cselect_b32 s10, 0, s10
    s_add_u32 s11, s10, 4096
    s_cmp_eq_u32 s11, 53248
    s_cselect_b32 s11, 0, s11
    s_add_u32 s12, s11, 4096
    s_cmp_eq_u32 s12, 53248
    s_cselect_b32 s12, 0, s12
    s_add_u32 s13, s12, 4096
    s_cmp_eq_u32 s13, 53248
    s_cselect_b32 s13, 0, s13
    s_add_u32 s14, s13, 4096
    s_cmp_eq_u32 s14, 53248
    s_cselect_b32 s14, 0, s14
    s_add_u32 s15, s14, 4096
    s_cmp_eq_u32 s15, 53248
    s_cselect_b32 s15, 0, s15
    s_add_u32 s16, s15, 4096
    s_cmp_eq_u32 s16, 53248
    s_cselect_b32 s16, 0, s16
    s_mov_b32 s17, 53248
    s_lshl2_add_u32 s94, s66, 0
    s_mul_i32 s88, s94, 55296
    s_mul_i32 s94, s94, 20480
    s_lshl2_add_u32 s95, s66, 1
    s_mul_i32 s89, s95, 55296
    s_mul_i32 s95, s95, 20480
    s_add_u32 s96, s68, 0
    s_mul_i32 s90, s96, 55296
    s_mul_i32 s96, s96, 20480
    s_add_u32 s97, s68, 1
    s_mul_i32 s91, s97, 55296
    s_mul_i32 s97, s97, 20480
    s_lshl2_add_u32 s98, s66, 2
    s_mul_i32 s92, s98, 55296
    s_mul_i32 s98, s98, 20480
    s_lshl2_add_u32 s99, s66, 3
    s_mul_i32 s93, s99, 55296
    s_mul_i32 s99, s99, 20480
    s_waitcnt vmcnt(37)
    ds_read_b64_tr_b16 a[0:1], v224 offset:0
    ds_read_b64_tr_b16 a[2:3], v224 offset:2048
    ds_read_b64_tr_b16 a[4:5], v225 offset:0
    ds_read_b64_tr_b16 a[6:7], v225 offset:2048
    ds_read_b64_tr_b16 a[8:9], v226 offset:0
    ds_read_b64_tr_b16 a[10:11], v226 offset:2048
    ds_read_b64_tr_b16 a[12:13], v227 offset:0
    ds_read_b64_tr_b16 a[14:15], v227 offset:2048
    s_waitcnt vmcnt(33)
    ds_read_b64_tr_b16 a[16:17], v224 offset:16384
    ds_read_b64_tr_b16 a[18:19], v224 offset:18432
    ds_read_b64_tr_b16 a[20:21], v225 offset:16384
    ds_read_b64_tr_b16 a[22:23], v225 offset:18432
    ds_read_b64_tr_b16 a[24:25], v226 offset:16384
    ds_read_b64_tr_b16 a[26:27], v226 offset:18432
    ds_read_b64_tr_b16 a[28:29], v227 offset:16384
    ds_read_b64_tr_b16 a[30:31], v227 offset:18432
    s_waitcnt vmcnt(29)
    ds_read_b64_tr_b16 a[32:33], v224 offset:32768
    ds_read_b64_tr_b16 a[34:35], v224 offset:34816
    ds_read_b64_tr_b16 a[36:37], v225 offset:32768
    ds_read_b64_tr_b16 a[38:39], v225 offset:34816
    ds_read_b64_tr_b16 a[40:41], v226 offset:32768
    ds_read_b64_tr_b16 a[42:43], v226 offset:34816
    ds_read_b64_tr_b16 a[44:45], v227 offset:32768
    ds_read_b64_tr_b16 a[46:47], v227 offset:34816
    s_waitcnt vmcnt(25)
    ds_read_b64_tr_b16 a[48:49], v224 offset:49152
    ds_read_b64_tr_b16 a[50:51], v224 offset:51200
    ds_read_b64_tr_b16 a[52:53], v225 offset:49152
    ds_read_b64_tr_b16 a[54:55], v225 offset:51200
    ds_read_b64_tr_b16 a[56:57], v226 offset:49152
    ds_read_b64_tr_b16 a[58:59], v226 offset:51200
    ds_read_b64_tr_b16 a[60:61], v227 offset:49152
    ds_read_b64_tr_b16 a[62:63], v227 offset:51200
    s_waitcnt lgkmcnt(15)
    s_add_u32 m0, s57, 0
    s_nop 0
    buffer_load_dwordx4 v18, s[32:35], s70 offen offset:0 lds
    buffer_load_dwordx4 v19, s[32:35], s70 offen offset:1024 lds
    buffer_load_dwordx4 v20, s[32:35], s70 offen offset:2048 lds
    buffer_load_dwordx4 v21, s[32:35], s70 offen offset:3072 lds
    s_add_u32 s70, s70, 163840
    s_cmp_eq_u32 s70, 2129920
    s_cselect_b32 s70, 0, s70
    s_add_u32 m0, s57, 16384
    s_nop 0
    buffer_load_dwordx4 v18, s[32:35], s70 offen offset:0 lds
    buffer_load_dwordx4 v19, s[32:35], s70 offen offset:1024 lds
    buffer_load_dwordx4 v20, s[32:35], s70 offen offset:2048 lds
    buffer_load_dwordx4 v21, s[32:35], s70 offen offset:3072 lds
    s_add_u32 s70, s70, 163840
    s_cmp_eq_u32 s70, 2129920
    s_cselect_b32 s70, 0, s70
    s_waitcnt lgkmcnt(8)
    s_add_u32 m0, s57, 32768
    s_nop 0
    buffer_load_dwordx4 v18, s[32:35], s70 offen offset:0 lds
    buffer_load_dwordx4 v19, s[32:35], s70 offen offset:1024 lds
    buffer_load_dwordx4 v20, s[32:35], s70 offen offset:2048 lds
    buffer_load_dwordx4 v21, s[32:35], s70 offen offset:3072 lds
    s_waitcnt lgkmcnt(0)
    v_add_u32 v18, s71, v18
    v_add_u32 v19, s71, v19
    v_add_u32 v20, s71, v20
    v_add_u32 v21, s71, v21
    s_mov_b32 s70, 2129920
    s_add_u32 m0, s57, 49152
    s_nop 0
    buffer_load_dwordx4 v18, s[32:35], s70 offen offset:0 lds
    buffer_load_dwordx4 v19, s[32:35], s70 offen offset:1024 lds
    buffer_load_dwordx4 v20, s[32:35], s70 offen offset:2048 lds
    buffer_load_dwordx4 v21, s[32:35], s70 offen offset:3072 lds
    s_sub_u32 s62, s72, 28
    s_lshl2_add_u32 s62, s62, s56
    s_mov_b64 exec, 0
    s_cmpk_eq_u32 s56, 1
    s_cbranch_scc1 L_hqI1
    s_cmpk_eq_u32 s56, 2
    s_cbranch_scc1 L_hqI2
    s_cmpk_eq_u32 s56, 3
    s_cbranch_scc1 L_hqI3
L_hqI0:
    s_cmpk_eq_u32 s62, 0
    s_cbranch_scc1 L_hpI0
    s_cmpk_eq_u32 s62, 4
    s_cbranch_scc1 L_hpI4
    s_cmpk_eq_u32 s62, 8
    s_cbranch_scc1 L_hpI8
    s_cmpk_eq_u32 s62, 12
    s_cbranch_scc1 L_hpI12
    s_branch L_hpI_back0
L_hqI1:
    s_cmpk_eq_u32 s62, 1
    s_cbranch_scc1 L_hpI1
    s_cmpk_eq_u32 s62, 5
    s_cbranch_scc1 L_hpI5
    s_cmpk_eq_u32 s62, 9
    s_cbranch_scc1 L_hpI9
    s_cmpk_eq_u32 s62, 13
    s_cbranch_scc1 L_hpI13
    s_branch L_hpI_back0
L_hqI2:
    s_cmpk_eq_u32 s62, 2
    s_cbranch_scc1 L_hpI2
    s_cmpk_eq_u32 s62, 6
    s_cbranch_scc1 L_hpI6
    s_cmpk_eq_u32 s62, 10
    s_cbranch_scc1 L_hpI10
    s_branch L_hpI_back0
L_hqI3:
    s_cmpk_eq_u32 s62, 3
    s_cbranch_scc1 L_hpI3
    s_cmpk_eq_u32 s62, 7
    s_cbranch_scc1 L_hpI7
    s_cmpk_eq_u32 s62, 11
    s_cbranch_scc1 L_hpI11
L_hpI_back0:
L_hpI_done:
    s_mov_b64 exec, -1
L_hpI0:
    s_cbranch_execz L_hpI_back0
    s_waitcnt vmcnt(16)
    v_lshlrev_b32 v56, 16, v60
    v_and_b32 v57, 0xffff0000, v60
L_hpI1:
    s_cbranch_execz L_hpI_back0
    v_lshlrev_b32 v58, 16, v61
    v_and_b32 v59, 0xffff0000, v61
    ds_read_b64_tr_b16 a[64:65], v228 offset:0
    ds_read_b64_tr_b16 a[66:67], v228 offset:2048
    ds_read_b64_tr_b16 a[68:69], v229 offset:0
    ds_read_b64_tr_b16 a[70:71], v229 offset:2048
    ds_read_b64_tr_b16 a[72:73], v230 offset:0
    ds_read_b64_tr_b16 a[74:75], v230 offset:2048
    ds_read_b64_tr_b16 a[76:77], v231 offset:0
    ds_read_b64_tr_b16 a[78:79], v231 offset:2048
    ds_read_b64_tr_b16 a[80:81], v228 offset:16384
    ds_read_b64_tr_b16 a[82:83], v228 offset:18432
    ds_read_b64_tr_b16 a[84:85], v229 offset:16384
    ds_read_b64_tr_b16 a[86:87], v229 offset:18432
    ds_read_b64_tr_b16 a[88:89], v230 offset:16384
    ds_read_b64_tr_b16 a[90:91], v230 offset:18432
L_hpI2:
    s_cbranch_execz L_hpI_back0
    ds_read_b64_tr_b16 a[92:93], v231 offset:16384
    ds_read_b64_tr_b16 a[94:95], v231 offset:18432
    ds_read_b64_tr_b16 a[96:97], v228 offset:32768
    ds_read_b64_tr_b16 a[98:99], v228 offset:34816
    ds_read_b64_tr_b16 a[100:101], v229 offset:32768
    ds_read_b64_tr_b16 a[102:103], v229 offset:34816
    ds_read_b64_tr_b16 a[104:105], v230 offset:32768
    ds_read_b64_tr_b16 a[106:107], v230 offset:34816
    ds_read_b64_tr_b16 a[108:109], v231 offset:32768
    ds_read_b64_tr_b16 a[110:111], v231 offset:34816
    ds_read_b64_tr_b16 a[112:113], v228 offset:49152
    ds_read_b64_tr_b16 a[114:115], v228 offset:51200
    ds_read_b64_tr_b16 a[116:117], v229 offset:49152
    ds_read_b64_tr_b16 a[118:119], v229 offset:51200
    ds_read_b64_tr_b16 a[120:121], v230 offset:49152
L_hpI3:
    s_cbranch_execz L_hpI_back0
    ds_read_b64_tr_b16 a[122:123], v230 offset:51200
    ds_read_b64_tr_b16 a[124:125], v231 offset:49152
    ds_read_b64_tr_b16 a[126:127], v231 offset:51200
    ds_read_b64_tr_b16 a[128:129], v232 offset:0
    ds_read_b64_tr_b16 a[130:131], v232 offset:2048
    ds_read_b64_tr_b16 a[132:133], v233 offset:0
    ds_read_b64_tr_b16 a[134:135], v233 offset:2048
    ds_read_b64_tr_b16 a[136:137], v234 offset:0
    ds_read_b64_tr_b16 a[138:139], v234 offset:2048
    ds_read_b64_tr_b16 a[140:141], v235 offset:0
    ds_read_b64_tr_b16 a[142:143], v235 offset:2048
    ds_read_b64_tr_b16 a[144:145], v232 offset:16384
    ds_read_b64_tr_b16 a[146:147], v232 offset:18432
    ds_read_b64_tr_b16 a[148:149], v233 offset:16384
    ds_read_b64_tr_b16 a[150:151], v233 offset:18432
    ds_read_b64_tr_b16 a[152:153], v234 offset:16384
L_hpI4:
    s_cbranch_execz L_hpI_back0
    ds_read_b64_tr_b16 a[154:155], v234 offset:18432
    ds_read_b64_tr_b16 a[156:157], v235 offset:16384
    ds_read_b64_tr_b16 a[158:159], v235 offset:18432
    s_waitcnt vmcnt(12)
    ds_read_b64_tr_b16 a[160:161], v224 offset:0
    ds_read_b64_tr_b16 a[162:163], v224 offset:2048
    ds_read_b64_tr_b16 a[164:165], v225 offset:0
    ds_read_b64_tr_b16 a[166:167], v225 offset:2048
    ds_read_b64_tr_b16 a[168:169], v226 offset:0
    ds_read_b64_tr_b16 a[170:171], v226 offset:2048
    ds_read_b64_tr_b16 a[172:173], v227 offset:0
    ds_read_b64_tr_b16 a[174:175], v227 offset:2048
    s_waitcnt vmcnt(8)
    ds_read_b64_tr_b16 a[176:177], v224 offset:16384
    ds_read_b64_tr_b16 a[178:179], v224 offset:18432
    ds_read_b64_tr_b16 a[180:181], v225 offset:16384
L_hpI5:
    s_cbranch_execz L_hpI_back0
    ds_read_b64_tr_b16 a[182:183], v225 offset:18432
    ds_read_b64_tr_b16 a[184:185], v226 offset:16384
    ds_read_b64_tr_b16 a[186:187], v226 offset:18432
    ds_read_b64_tr_b16 a[188:189], v227 offset:16384
    ds_read_b64_tr_b16 a[190:191], v227 offset:18432
    s_waitcnt vmcnt(4)
    ds_read_b64_tr_b16 a[192:193], v224 offset:32768
    ds_read_b64_tr_b16 a[194:195], v224 offset:34816
    ds_read_b64_tr_b16 a[196:197], v225 offset:32768
    ds_read_b64_tr_b16 a[198:199], v225 offset:34816
    ds_read_b64_tr_b16 a[200:201], v226 offset:32768
    ds_read_b64_tr_b16 a[202:203], v226 offset:34816
    ds_read_b64_tr_b16 a[204:205], v227 offset:32768
    ds_read_b64_tr_b16 a[206:207], v227 offset:34816
    s_waitcnt vmcnt(0)
    ds_read_b64_tr_b16 a[208:209], v224 offset:49152
    ds_read_b64_tr_b16 a[210:211], v224 offset:51200
L_hpI6:
    s_cbranch_execz L_hpI_back0
    ds_read_b64_tr_b16 a[212:213], v225 offset:49152
    ds_read_b64_tr_b16 a[214:215], v225 offset:51200
    ds_read_b64_tr_b16 a[216:217], v226 offset:49152
    ds_read_b64_tr_b16 a[218:219], v226 offset:51200
    ds_read_b64_tr_b16 a[220:221], v227 offset:49152
    ds_read_b64_tr_b16 a[222:223], v227 offset:51200
    s_waitcnt lgkmcnt(0)
    s_cmp_lg_u32 s56, 0
    s_cbranch_scc1 L_poll_ok
    s_mov_b32 s74, 0
L_dbg2:
    v_mov_b32 v2, 0
    buffer_load_dword v244, v2, s[44:47], 0 offen sc1
    s_waitcnt vmcnt(0)
    v_cmp_gt_u32 vcc, 32, v244
    s_cbranch_vccz L_dbg2_ok
    s_sleep 4
    s_add_u32 s74, s74, 1
    s_cmp_lt_u32 s74, 200000
    s_cbranch_scc1 L_dbg2
L_dbg2_ok:
    s_mov_b32 s74, 0
L_poll:
    v_mov_b32 v251, 0
    s_mov_b64 exec, 3
L_hpI7:
    s_cbranch_execz L_hpI_back0
    buffer_atomic_add v251, v243, s[52:55], 0 offen offset:0 sc0 sc1
    s_mov_b64 exec, -1
    s_waitcnt vmcnt(0)
    s_mov_b64 exec, 3
    v_cmp_gt_u32 vcc, 27, v251
    s_mov_b64 exec, -1
    s_cbranch_vccz L_poll_ok
    s_sleep 4
    s_add_u32 s74, s74, 1
    s_cmp_lt_u32 s74, 200000
    s_cbranch_scc1 L_poll
L_poll_ok:
    s_barrier
    v_add_u32 v236, s88, v246
    v_add_u32 v237, s88, v247
    buffer_load_dwordx4 v[160:163], v236, s[48:51], s4 offen sc1
    buffer_load_dwordx4 v[164:167], v236, s[48:51], s5 offen sc1
    buffer_load_dwordx4 v[168:171], v236, s[48:51], s6 offen sc1
    buffer_load_dwordx4 v[172:175], v236, s[48:51], s7 offen sc1
    buffer_load_dwordx4 v[176:179], v236, s[48:51], s8 offen sc1
    buffer_load_dwordx4 v[180:183], v236, s[48:51], s9 offen sc1
    buffer_load_dwordx4 v[184:187], v236, s[48:51], s10 offen sc1
    buffer_load_dwordx4 v[188:191], v236, s[48:51], s11 offen sc1
    s_waitcnt vmcnt(7)
    v_mfma_f32_16x16x32_bf16 v[64:67], a[0:3], v[160:163], 0
    buffer_load_dwordx4 v[192:195], v236, s[48:51], s12 offen sc1
    v_mfma_f32_16x16x32_bf16 v[68:71], a[4:7], v[160:163], 0
    v_mfma_f32_16x16x32_bf16 v[72:75], a[8:11], v[160:163], 0
    buffer_load_dwordx4 v[196:199], v236, s[48:51], s13 offen sc1
    v_mfma_f32_16x16x32_bf16 v[76:79], a[12:15], v[160:163], 0
    s_waitcnt vmcnt(8)
    v_mfma_f32_16x16x32_bf16 v[64:67], a[16:19], v[164:167], v[64:67]
    buffer_load_dwordx4 v[200:203], v236, s[48:51], s14 offen sc1
    v_mfma_f32_16x16x32_bf16 v[68:71], a[20:23], v[164:167], v[68:71]
    v_mfma_f32_16x16x32_bf16 v[72:75], a[24:27], v[164:167], v[72:75]
    buffer_load_dwordx4 v[204:207], v236, s[48:51], s15 offen sc1
    v_mfma_f32_16x16x32_bf16 v[76:79], a[28:31], v[164:167], v[76:79]
    s_waitcnt vmcnt(9)
    v_mfma_f32_16x16x32_bf16 v[64:67], a[32:35], v[168:171], v[64:67]
    buffer_load_dwordx4 v[208:211], v236, s[48:51], s16 offen sc1
    v_mfma_f32_16x16x32_bf16 v[68:71], a[36:39], v[168:171], v[68:71]
    v_mfma_f32_16x16x32_bf16 v[72:75], a[40:43], v[168:171], v[72:75]
    v_mfma_f32_16x16x32_bf16 v[76:79], a[44:47], v[168:171], v[76:79]
    s_waitcnt vmcnt(9)
    v_mfma_f32_16x16x32_bf16 v[64:67], a[48:51], v[172:175], v[64:67]
    buffer_load_dwordx4 v[212:215], v237, s[48:51], s17 offen sc1
    v_mfma_f32_16x16x32_bf16 v[68:71], a[52:55], v[172:175], v[68:71]
    v_mfma_f32_16x16x32_bf16 v[72:75], a[56:59], v[172:175], v[72:75]
    v_mfma_f32_16x16x32_bf16 v[76:79], a[60:63], v[172:175], v[76:79]
    s_waitcnt vmcnt(9)
    v_mfma_f32_16x16x32_bf16 v[64:67], a[64:67], v[176:179], v[64:67]
    v_add_u32 v236, s89, v246
    v_mfma_f32_16x16x32_bf16 v[68:71], a[68:71], v[176:179], v[68:71]
    v_add_u32 v237, s89, v247
    v_mfma_f32_16x16x32_bf16 v[72:75], a[72:75], v[176:179], v[72:75]
    buffer_load_dwordx4 v[160:163], v236, s[48:51], s4 offen sc1
    v_mfma_f32_16x16x32_bf16 v[76:79], a[76:79], v[176:179], v[76:79]
    s_waitcnt vmcnt(9)
    v_mfma_f32_16x16x32_bf16 v[64:67], a[80:83], v[180:183], v[64:67]
    buffer_load_dwordx4 v[164:167], v236, s[48:51], s5 offen sc1
    v_mfma_f32_16x16x32_bf16 v[68:71], a[84:87], v[180:183], v[68:71]
    v_mfma_f32_16x16x32_bf16 v[72:75], a[88:91], v[180:183], v[72:75]
    v_mfma_f32_16x16x32_bf16 v[76:79], a[92:95], v[180:183], v[76:79]
    s_waitcnt vmcnt(9)
    v_mfma_f32_16x16x32_bf16 v[64:67], a[96:99], v[184:187], v[64:67]
    buffer_load_dwordx4 v[168:171], v236, s[48:51], s6 offen sc1
    v_mfma_f32_16x16x32_bf16 v[68:71], a[100:103], v[184:187], v[68:71]
    v_mfma_f32_16x16x32_bf16 v[72:75], a[104:107], v[184:187], v[72:75]
    v_mfma_f32_16x16x32_bf16 v[76:79], a[108:111], v[184:187], v[76:79]
    s_waitcnt vmcnt(9)
    v_mfma_f32_16x16x32_bf16 v[64:67], a[112:115], v[188:191], v[64:67]
    buffer_load_dwordx4 v[172:175], v236, s[48:51], s7 offen sc1
    v_mfma_f32_16x16x32_bf16 v[68:71], a[116:119], v[188:191], v[68:71]
    v_mfma_f32_16x16x32_bf16 v[72:75], a[120:123], v[188:191], v[72:75]
    v_mfma_f32_16x16x32_bf16 v[76:79], a[124:127], v[188:191], v[76:79]
    s_waitcnt vmcnt(9)
L_hpI8:
    s_cbranch_execz L_hpI_back0
    v_mfma_f32_16x16x32_bf16 v[64:67], a[128:131], v[192:195], v[64:67]
    buffer_load_dwordx4 v[176:179], v236, s[48:51], s8 offen sc1
    v_mfma_f32_16x16x32_bf16 v[68:71], a[132:135], v[192:195], v[68:71]
    v_mfma_f32_16x16x32_bf16 v[72:75], a[136:139], v[192:195], v[72:75]
    v_mfma_f32_16x16x32_bf16 v[76:79], a[140:143], v[192:195], v[76:79]
    s_waitcnt vmcnt(9)
    v_mfma_f32_16x16x32_bf16 v[64:67], a[144:147], v[196:199], v[64:67]
    buffer_load_dwordx4 v[180:183], v236, s[48:51], s9 offen sc1
    v_mfma_f32_16x16x32_bf16 v[68:71], a[148:151], v[196:199], v[68:71]
    v_mfma_f32_16x16x32_bf16 v[72:75], a[152:155], v[196:199], v[72:75]
    v_mfma_f32_16x16x32_bf16 v[76:79], a[156:159], v[196:199], v[76:79]
    s_waitcnt vmcnt(9)
    v_mfma_f32_16x16x32_bf16 v[64:67], a[160:163], v[200:203], v[64:67]
    buffer_load_dwordx4 v[184:187], v236, s[48:51], s10 offen sc1
    v_mfma_f32_16x16x32_bf16 v[68:71], a[164:167], v[200:203], v[68:71]
    v_mfma_f32_16x16x32_bf16 v[72:75], a[168:171], v[200:203], v[72:75]
    v_mfma_f32_16x16x32_bf16 v[76:79], a[172:175], v[200:203], v[76:79]
    s_waitcnt vmcnt(9)
    v_mfma_f32_16x16x32_bf16 v[64:67], a[176:179], v[204:207], v[64:67]
    buffer_load_dwordx4 v[188:191], v236, s[48:51], s11 offen sc1
    v_mfma_f32_16x16x32_bf16 v[68:71], a[180:183], v[204:207], v[68:71]
    v_mfma_f32_16x16x32_bf16 v[72:75], a[184:187], v[204:207], v[72:75]
    v_mfma_f32_16x16x32_bf16 v[76:79], a[188:191], v[204:207], v[76:79]
    s_waitcnt vmcnt(9)
    v_mfma_f32_16x16x32_bf16 v[64:67], a[192:195], v[208:211], v[64:67]
    buffer_load_dwordx4 v[192:195], v236, s[48:51], s12 offen sc1
    v_mfma_f32_16x16x32_bf16 v[68:71], a[196:199], v[208:211], v[68:71]
    v_mfma_f32_16x16x32_bf16 v[72:75], a[200:203], v[208:211], v[72:75]
    v_mfma_f32_16x16x32_bf16 v[76:79], a[204:207], v[208:211], v[76:79]
    s_waitcnt vmcnt(9)
    v_mfma_f32_16x16x32_bf16 v[64:67], a[208:211], v[212:215], v[64:67]
    buffer_load_dwordx4 v[196:199], v236, s[48:51], s13 offen sc1
    v_mfma_f32_16x16x32_bf16 v[68:71], a[212:215], v[212:215], v[68:71]
    v_mfma_f32_16x16x32_bf16 v[72:75], a[216:219], v[212:215], v[72:75]
    v_mfma_f32_16x16x32_bf16 v[76:79], a[220:223], v[212:215], v[76:79]
    s_waitcnt vmcnt(9)
    v_mfma_f32_16x16x32_bf16 v[80:83], a[0:3], v[160:163], 0
    buffer_load_dwordx4 v[200:203], v236, s[48:51], s14 offen sc1
    v_mfma_f32_16x16x32_bf16 v[84:87], a[4:7], v[160:163], 0
    v_mfma_f32_16x16x32_bf16 v[88:91], a[8:11], v[160:163], 0
    v_mfma_f32_16x16x32_bf16 v[92:95], a[12:15], v[160:163], 0
    s_waitcnt vmcnt(9)
    v_mfma_f32_16x16x32_bf16 v[80:83], a[16:19], v[164:167], v[80:83]
    buffer_load_dwordx4 v[204:207], v236, s[48:51], s15 offen sc1
    v_mfma_f32_16x16x32_bf16 v[84:87], a[20:23], v[164:167], v[84:87]
    v_mfma_f32_16x16x32_bf16 v[88:91], a[24:27], v[164:167], v[88:91]
    ds_write_b128 v240, v[64:67] offset:0
    v_mfma_f32_16x16x32_bf16 v[92:95], a[28:31], v[164:167], v[92:95]
    s_waitcnt vmcnt(9)
    v_mfma_f32_16x16x32_bf16 v[80:83], a[32:35], v[168:171], v[80:83]
    buffer_load_dwordx4 v[208:211], v236, s[48:51], s16 offen sc1
    v_mfma_f32_16x16x32_bf16 v[84:87], a[36:39], v[168:171], v[84:87]
    v_mfma_f32_16x16x32_bf16 v[88:91], a[40:43], v[168:171], v[88:91]
    ds_write_b128 v241, v[68:71] offset:0
    v_mfma_f32_16x16x32_bf16 v[92:95], a[44:47], v[168:171], v[92:95]
    s_waitcnt vmcnt(9)
    v_mfma_f32_16x16x32_bf16 v[80:83], a[48:51], v[172:175], v[80:83]
    buffer_load_dwordx4 v[212:215], v237, s[48:51], s17 offen sc1
    v_mfma_f32_16x16x32_bf16 v[84:87], a[52:55], v[172:175], v[84:87]
    v_mfma_f32_16x16x32_bf16 v[88:91], a[56:59], v[172:175], v[88:91]
    ds_write_b128 v240, v[72:75] offset:128
    v_mfma_f32_16x16x32_bf16 v[92:95], a[60:63], v[172:175], v[92:95]
    s_waitcnt vmcnt(9)
    v_mfma_f32_16x16x32_bf16 v[80:83], a[64:67], v[176:179], v[80:83]
    v_add_u32 v236, s90, v246
    v_mfma_f32_16x16x32_bf16 v[84:87], a[68:71], v[176:179], v[84:87]
    v_add_u32 v237, s90, v247
    v_mfma_f32_16x16x32_bf16 v[88:91], a[72:75], v[176:179], v[88:91]
    buffer_load_dwordx4 v[160:163], v236, s[48:51], s4 offen sc1
    v_mfma_f32_16x16x32_bf16 v[92:95], a[76:79], v[176:179], v[92:95]
    ds_write_b128 v241, v[76:79] offset:128
    s_waitcnt vmcnt(9)
    v_mfma_f32_16x16x32_bf16 v[80:83], a[80:83], v[180:183], v[80:83]
    buffer_load_dwordx4 v[164:167], v236, s[48:51], s5 offen sc1
    v_mfma_f32_16x16x32_bf16 v[84:87], a[84:87], v[180:183], v[84:87]
    v_mfma_f32_16x16x32_bf16 v[88:91], a[88:91], v[180:183], v[88:91]
    v_mfma_f32_16x16x32_bf16 v[92:95], a[92:95], v[180:183], v[92:95]
    s_waitcnt vmcnt(9)
    v_mfma_f32_16x16x32_bf16 v[80:83], a[96:99], v[184:187], v[80:83]
    buffer_load_dwordx4 v[168:171], v236, s[48:51], s6 offen sc1
    v_mfma_f32_16x16x32_bf16 v[84:87], a[100:103], v[184:187], v[84:87]
    s_waitcnt lgkmcnt(0)
    s_barrier
    v_mfma_f32_16x16x32_bf16 v[88:91], a[104:107], v[184:187], v[88:91]
    ds_read_b128 v[96:99], v242 offset:0
    v_mfma_f32_16x16x32_bf16 v[92:95], a[108:111], v[184:187], v[92:95]
    ds_read_b128 v[100:103], v242 offset:4096
    s_waitcnt vmcnt(9)
    v_mfma_f32_16x16x32_bf16 v[80:83], a[112:115], v[188:191], v[80:83]
    buffer_load_dwordx4 v[172:175], v236, s[48:51], s7 offen sc1
    v_mfma_f32_16x16x32_bf16 v[84:87], a[116:119], v[188:191], v[84:87]
    ds_read_b128 v[104:107], v242 offset:8192
    v_mfma_f32_16x16x32_bf16 v[88:91], a[120:123], v[188:191], v[88:91]
    ds_read_b128 v[108:111], v242 offset:12288
    v_mfma_f32_16x16x32_bf16 v[92:95], a[124:127], v[188:191], v[92:95]
    s_waitcnt vmcnt(9)
    v_mfma_f32_16x16x32_bf16 v[80:83], a[128:131], v[192:195], v[80:83]
    buffer_load_dwordx4 v[176:179], v236, s[48:51], s8 offen sc1
    v_mfma_f32_16x16x32_bf16 v[84:87], a[132:135], v[192:195], v[84:87]
    v_mfma_f32_16x16x32_bf16 v[88:91], a[136:139], v[192:195], v[88:91]
    v_mfma_f32_16x16x32_bf16 v[92:95], a[140:143], v[192:195], v[92:95]
    s_waitcnt vmcnt(9)
    v_mfma_f32_16x16x32_bf16 v[80:83], a[144:147], v[196:199], v[80:83]
    buffer_load_dwordx4 v[180:183], v236, s[48:51], s9 offen sc1
    s_waitcnt lgkmcnt(2)
    v_add_f32 v96, v96, v100
    v_mfma_f32_16x16x32_bf16 v[84:87], a[148:151], v[196:199], v[84:87]
    v_add_f32 v97, v97, v101
    v_mfma_f32_16x16x32_bf16 v[88:91], a[152:155], v[196:199], v[88:91]
    v_add_f32 v98, v98, v102
    v_mfma_f32_16x16x32_bf16 v[92:95], a[156:159], v[196:199], v[92:95]
    v_add_f32 v99, v99, v103
    s_waitcnt vmcnt(9)
    v_mfma_f32_16x16x32_bf16 v[80:83], a[160:163], v[200:203], v[80:83]
    buffer_load_dwordx4 v[184:187], v236, s[48:51], s10 offen sc1
    s_waitcnt lgkmcnt(0)
    v_add_f32 v104, v104, v108
    v_mfma_f32_16x16x32_bf16 v[84:87], a[164:167], v[200:203], v[84:87]
    v_add_f32 v105, v105, v109
    v_mfma_f32_16x16x32_bf16 v[88:91], a[168:171], v[200:203], v[88:91]
    v_add_f32 v106, v106, v110
    v_mfma_f32_16x16x32_bf16 v[92:95], a[172:175], v[200:203], v[92:95]
    v_add_f32 v107, v107, v111
    s_waitcnt vmcnt(9)
    v_mfma_f32_16x16x32_bf16 v[80:83], a[176:179], v[204:207], v[80:83]
    buffer_load_dwordx4 v[188:191], v236, s[48:51], s11 offen sc1
    v_add_f32 v96, v96, v56
    v_mfma_f32_16x16x32_bf16 v[84:87], a[180:183], v[204:207], v[84:87]
    v_add_f32 v97, v97, v57
    v_mfma_f32_16x16x32_bf16 v[88:91], a[184:187], v[204:207], v[88:91]
    v_add_f32 v98, v98, v58
    v_mfma_f32_16x16x32_bf16 v[92:95], a[188:191], v[204:207], v[92:95]
    v_add_f32 v99, v99, v59
    s_waitcnt vmcnt(9)
    v_mfma_f32_16x16x32_bf16 v[80:83], a[192:195], v[208:211], v[80:83]
    buffer_load_dwordx4 v[192:195], v236, s[48:51], s12 offen sc1
    v_add_f32 v96, v96, v104
    v_mfma_f32_16x16x32_bf16 v[84:87], a[196:199], v[208:211], v[84:87]
    v_add_f32 v97, v97, v105
    v_mfma_f32_16x16x32_bf16 v[88:91], a[200:203], v[208:211], v[88:91]
    v_add_f32 v98, v98, v106
    v_mfma_f32_16x16x32_bf16 v[92:95], a[204:207], v[208:211], v[92:95]
    v_add_f32 v99, v99, v107
    s_waitcnt vmcnt(9)
    v_mfma_f32_16x16x32_bf16 v[80:83], a[208:211], v[212:215], v[80:83]
    buffer_load_dwordx4 v[196:199], v236, s[48:51], s13 offen sc1
    v_mfma_f32_16x16x32_bf16 v[84:87], a[212:215], v[212:215], v[84:87]
    v_cvt_pk_bf16_f32 v112, v96, v97
L_hpI9:
    s_cbranch_execz L_hpI_back0
    v_mfma_f32_16x16x32_bf16 v[88:91], a[216:219], v[212:215], v[88:91]
    v_cvt_pk_bf16_f32 v113, v98, v99
    v_mfma_f32_16x16x32_bf16 v[92:95], a[220:223], v[212:215], v[92:95]
    s_waitcnt vmcnt(9)
    v_mfma_f32_16x16x32_bf16 v[64:67], a[0:3], v[160:163], 0
    buffer_load_dwordx4 v[200:203], v236, s[48:51], s14 offen sc1
    v_mfma_f32_16x16x32_bf16 v[68:71], a[4:7], v[160:163], 0
    v_mfma_f32_16x16x32_bf16 v[72:75], a[8:11], v[160:163], 0
    v_mfma_f32_16x16x32_bf16 v[76:79], a[12:15], v[160:163], 0
    s_waitcnt vmcnt(9)
    v_mfma_f32_16x16x32_bf16 v[64:67], a[16:19], v[164:167], v[64:67]
    buffer_load_dwordx4 v[204:207], v236, s[48:51], s15 offen sc1
    v_mfma_f32_16x16x32_bf16 v[68:71], a[20:23], v[164:167], v[68:71]
    v_mfma_f32_16x16x32_bf16 v[72:75], a[24:27], v[164:167], v[72:75]
    ds_write_b128 v240, v[80:83] offset:16384
    v_mfma_f32_16x16x32_bf16 v[76:79], a[28:31], v[164:167], v[76:79]
    s_waitcnt vmcnt(9)
    v_mfma_f32_16x16x32_bf16 v[64:67], a[32:35], v[168:171], v[64:67]
    buffer_load_dwordx4 v[208:211], v236, s[48:51], s16 offen sc1
    v_mfma_f32_16x16x32_bf16 v[68:71], a[36:39], v[168:171], v[68:71]
    v_mfma_f32_16x16x32_bf16 v[72:75], a[40:43], v[168:171], v[72:75]
    ds_write_b128 v241, v[84:87] offset:16384
    v_mfma_f32_16x16x32_bf16 v[76:79], a[44:47], v[168:171], v[76:79]
    s_waitcnt vmcnt(9)
    v_mfma_f32_16x16x32_bf16 v[64:67], a[48:51], v[172:175], v[64:67]
    buffer_load_dwordx4 v[212:215], v237, s[48:51], s17 offen sc1
    v_mfma_f32_16x16x32_bf16 v[68:71], a[52:55], v[172:175], v[68:71]
    v_mfma_f32_16x16x32_bf16 v[72:75], a[56:59], v[172:175], v[72:75]
    ds_write_b128 v240, v[88:91] offset:16512
    v_mfma_f32_16x16x32_bf16 v[76:79], a[60:63], v[172:175], v[76:79]
    s_waitcnt vmcnt(9)
    v_mfma_f32_16x16x32_bf16 v[64:67], a[64:67], v[176:179], v[64:67]
    v_add_u32 v236, s91, v246
    v_mfma_f32_16x16x32_bf16 v[68:71], a[68:71], v[176:179], v[68:71]
    v_add_u32 v237, s91, v247
    v_mfma_f32_16x16x32_bf16 v[72:75], a[72:75], v[176:179], v[72:75]
    buffer_load_dwordx4 v[160:163], v236, s[48:51], s4 offen sc1
    v_mfma_f32_16x16x32_bf16 v[76:79], a[76:79], v[176:179], v[76:79]
    ds_write_b128 v241, v[92:95] offset:16512
    s_waitcnt vmcnt(9)
    v_mfma_f32_16x16x32_bf16 v[64:67], a[80:83], v[180:183], v[64:67]
    buffer_load_dwordx4 v[164:167], v236, s[48:51], s5 offen sc1
    v_mfma_f32_16x16x32_bf16 v[68:71], a[84:87], v[180:183], v[68:71]
    v_mfma_f32_16x16x32_bf16 v[72:75], a[88:91], v[180:183], v[72:75]
    v_mfma_f32_16x16x32_bf16 v[76:79], a[92:95], v[180:183], v[76:79]
    s_waitcnt vmcnt(9)
    v_mfma_f32_16x16x32_bf16 v[64:67], a[96:99], v[184:187], v[64:67]
    buffer_load_dwordx4 v[168:171], v236, s[48:51], s6 offen sc1
    v_mfma_f32_16x16x32_bf16 v[68:71], a[100:103], v[184:187], v[68:71]
    s_waitcnt lgkmcnt(0)
    s_barrier
    v_mfma_f32_16x16x32_bf16 v[72:75], a[104:107], v[184:187], v[72:75]
    ds_read_b128 v[96:99], v242 offset:16384
    v_mfma_f32_16x16x32_bf16 v[76:79], a[108:111], v[184:187], v[76:79]
    ds_read_b128 v[100:103], v242 offset:20480
    s_waitcnt vmcnt(9)
    v_mfma_f32_16x16x32_bf16 v[64:67], a[112:115], v[188:191], v[64:67]
    buffer_load_dwordx4 v[172:175], v236, s[48:51], s7 offen sc1
    v_mfma_f32_16x16x32_bf16 v[68:71], a[116:119], v[188:191], v[68:71]
    ds_read_b128 v[104:107], v242 offset:24576
    v_mfma_f32_16x16x32_bf16 v[72:75], a[120:123], v[188:191], v[72:75]
    ds_read_b128 v[108:111], v242 offset:28672
    v_mfma_f32_16x16x32_bf16 v[76:79], a[124:127], v[188:191], v[76:79]
    s_waitcnt vmcnt(9)
    v_mfma_f32_16x16x32_bf16 v[64:67], a[128:131], v[192:195], v[64:67]
    buffer_load_dwordx4 v[176:179], v236, s[48:51], s8 offen sc1
    v_mfma_f32_16x16x32_bf16 v[68:71], a[132:135], v[192:195], v[68:71]
    v_mfma_f32_16x16x32_bf16 v[72:75], a[136:139], v[192:195], v[72:75]
    v_mfma_f32_16x16x32_bf16 v[76:79], a[140:143], v[192:195], v[76:79]
    s_waitcnt vmcnt(9)
    v_mfma_f32_16x16x32_bf16 v[64:67], a[144:147], v[196:199], v[64:67]
    buffer_load_dwordx4 v[180:183], v236, s[48:51], s9 offen sc1
    s_waitcnt lgkmcnt(2)
    v_add_f32 v96, v96, v100
    v_mfma_f32_16x16x32_bf16 v[68:71], a[148:151], v[196:199], v[68:71]
    v_add_f32 v97, v97, v101
    v_mfma_f32_16x16x32_bf16 v[72:75], a[152:155], v[196:199], v[72:75]
    v_add_f32 v98, v98, v102
    v_mfma_f32_16x16x32_bf16 v[76:79], a[156:159], v[196:199], v[76:79]
    v_add_f32 v99, v99, v103
    s_waitcnt vmcnt(9)
    v_mfma_f32_16x16x32_bf16 v[64:67], a[160:163], v[200:203], v[64:67]
    buffer_load_dwordx4 v[184:187], v236, s[48:51], s10 offen sc1
    s_waitcnt lgkmcnt(0)
    v_add_f32 v104, v104, v108
    v_mfma_f32_16x16x32_bf16 v[68:71], a[164:167], v[200:203], v[68:71]
    v_add_f32 v105, v105, v109
    v_mfma_f32_16x16x32_bf16 v[72:75], a[168:171], v[200:203], v[72:75]
    v_add_f32 v106, v106, v110
    v_mfma_f32_16x16x32_bf16 v[76:79], a[172:175], v[200:203], v[76:79]
    v_add_f32 v107, v107, v111
    s_waitcnt vmcnt(9)
    v_mfma_f32_16x16x32_bf16 v[64:67], a[176:179], v[204:207], v[64:67]
    buffer_load_dwordx4 v[188:191], v236, s[48:51], s11 offen sc1
    v_add_f32 v96, v96, v56
    v_mfma_f32_16x16x32_bf16 v[68:71], a[180:183], v[204:207], v[68:71]
    v_add_f32 v97, v97, v57
    v_mfma_f32_16x16x32_bf16 v[72:75], a[184:187], v[204:207], v[72:75]
    v_add_f32 v98, v98, v58
    v_mfma_f32_16x16x32_bf16 v[76:79], a[188:191], v[204:207], v[76:79]
    v_add_f32 v99, v99, v59
    s_waitcnt vmcnt(9)
    v_mfma_f32_16x16x32_bf16 v[64:67], a[192:195], v[208:211], v[64:67]
    v_mov_b32 v251, 0
    s_mov_b64 exec, 3
    buffer_atomic_add v251, v249, s[52:55], 0 offen offset:128 sc0 sc1
    s_mov_b64 exec, -1
    buffer_load_dwordx4 v[192:195], v236, s[48:51], s12 offen sc1
    v_mfma_f32_16x16x32_bf16 v[68:71], a[196:199], v[208:211], v[68:71]
    v_add_f32 v96, v96, v104
    v_mfma_f32_16x16x32_bf16 v[72:75], a[200:203], v[208:211], v[72:75]
    v_add_f32 v97, v97, v105
    v_add_f32 v98, v98, v106
    v_mfma_f32_16x16x32_bf16 v[76:79], a[204:207], v[208:211], v[76:79]
    v_add_f32 v99, v99, v107
    s_waitcnt vmcnt(10)
    v_mfma_f32_16x16x32_bf16 v[64:67], a[208:211], v[212:215], v[64:67]
    buffer_load_dwordx4 v[196:199], v236, s[48:51], s13 offen sc1
    v_mfma_f32_16x16x32_bf16 v[68:71], a[212:215], v[212:215], v[68:71]
    v_cvt_pk_bf16_f32 v114, v96, v97
    v_mfma_f32_16x16x32_bf16 v[72:75], a[216:219], v[212:215], v[72:75]
    v_cvt_pk_bf16_f32 v115, v98, v99
    v_mfma_f32_16x16x32_bf16 v[76:79], a[220:223], v[212:215], v[76:79]
    s_waitcnt vmcnt(10)
    v_mfma_f32_16x16x32_bf16 v[80:83], a[0:3], v[160:163], 0
    buffer_load_dwordx4 v[200:203], v236, s[48:51], s14 offen sc1
    v_mfma_f32_16x16x32_bf16 v[84:87], a[4:7], v[160:163], 0
    v_mfma_f32_16x16x32_bf16 v[88:91], a[8:11], v[160:163], 0
    v_mfma_f32_16x16x32_bf16 v[92:95], a[12:15], v[160:163], 0
    s_waitcnt vmcnt(10)
    v_mfma_f32_16x16x32_bf16 v[80:83], a[16:19], v[164:167], v[80:83]
    buffer_load_dwordx4 v[204:207], v236, s[48:51], s15 offen sc1
    v_mfma_f32_16x16x32_bf16 v[84:87], a[20:23], v[164:167], v[84:87]
    v_mfma_f32_16x16x32_bf16 v[88:91], a[24:27], v[164:167], v[88:91]
    ds_write_b128 v240, v[64:67] offset:0
    v_mfma_f32_16x16x32_bf16 v[92:95], a[28:31], v[164:167], v[92:95]
    s_waitcnt vmcnt(10)
    v_mfma_f32_16x16x32_bf16 v[80:83], a[32:35], v[168:171], v[80:83]
    buffer_load_dwordx4 v[208:211], v236, s[48:51], s16 offen sc1
    v_mfma_f32_16x16x32_bf16 v[84:87], a[36:39], v[168:171], v[84:87]
    v_mfma_f32_16x16x32_bf16 v[88:91], a[40:43], v[168:171], v[88:91]
    ds_write_b128 v241, v[68:71] offset:0
    v_mfma_f32_16x16x32_bf16 v[92:95], a[44:47], v[168:171], v[92:95]
    s_waitcnt vmcnt(10)
    v_mfma_f32_16x16x32_bf16 v[80:83], a[48:51], v[172:175], v[80:83]
    buffer_load_dwordx4 v[212:215], v237, s[48:51], s17 offen sc1
    v_mfma_f32_16x16x32_bf16 v[84:87], a[52:55], v[172:175], v[84:87]
    v_mfma_f32_16x16x32_bf16 v[88:91], a[56:59], v[172:175], v[88:91]
    ds_write_b128 v240, v[72:75] offset:128
L_hpI10:
    s_cbranch_execz L_hpI_back0
    v_mfma_f32_16x16x32_bf16 v[92:95], a[60:63], v[172:175], v[92:95]
    s_waitcnt vmcnt(10)
    v_mfma_f32_16x16x32_bf16 v[80:83], a[64:67], v[176:179], v[80:83]
    ds_write_b128 v241, v[76:79] offset:128
    v_mfma_f32_16x16x32_bf16 v[84:87], a[68:71], v[176:179], v[84:87]
    v_mfma_f32_16x16x32_bf16 v[88:91], a[72:75], v[176:179], v[88:91]
    v_mfma_f32_16x16x32_bf16 v[92:95], a[76:79], v[176:179], v[92:95]
    s_waitcnt vmcnt(9)
    v_mfma_f32_16x16x32_bf16 v[80:83], a[80:83], v[180:183], v[80:83]
    v_mfma_f32_16x16x32_bf16 v[84:87], a[84:87], v[180:183], v[84:87]
    v_mfma_f32_16x16x32_bf16 v[88:91], a[88:91], v[180:183], v[88:91]
    v_mfma_f32_16x16x32_bf16 v[92:95], a[92:95], v[180:183], v[92:95]
    s_waitcnt vmcnt(8)
    v_mfma_f32_16x16x32_bf16 v[80:83], a[96:99], v[184:187], v[80:83]
    s_cmp_lg_u32 s56, 0
    s_cbranch_scc1 L_poll3_ok
    s_mov_b64 exec, 3
    s_waitcnt vmcnt(6)
    v_cmp_gt_u32 vcc, 27, v251
    s_mov_b64 exec, -1
    s_cbranch_vccz L_poll3_ok
    s_mov_b32 s74, 0
L_poll3:
    v_mov_b32 v251, 0
    s_mov_b64 exec, 3
    buffer_atomic_add v251, v249, s[52:55], 0 offen offset:128 sc0 sc1
    s_mov_b64 exec, -1
    s_waitcnt vmcnt(0)
    s_mov_b64 exec, 3
    v_cmp_gt_u32 vcc, 27, v251
    s_mov_b64 exec, -1
    s_cbranch_vccz L_poll3_ok
    s_sleep 4
    s_add_u32 s74, s74, 1
    s_cmp_lt_u32 s74, 200000
    s_cbranch_scc1 L_poll3
L_poll3_ok:
    v_mfma_f32_16x16x32_bf16 v[84:87], a[100:103], v[184:187], v[84:87]
    s_waitcnt lgkmcnt(0)
    s_barrier
    v_mfma_f32_16x16x32_bf16 v[88:91], a[104:107], v[184:187], v[88:91]
    ds_read_b128 v[96:99], v242 offset:0
    v_mfma_f32_16x16x32_bf16 v[92:95], a[108:111], v[184:187], v[92:95]
    ds_read_b128 v[100:103], v242 offset:4096
    s_waitcnt vmcnt(7)
    v_mfma_f32_16x16x32_bf16 v[80:83], a[112:115], v[188:191], v[80:83]
    v_add_u32 v236, s92, v246
    v_add_u32 v237, s92, v247
    v_mfma_f32_16x16x32_bf16 v[84:87], a[116:119], v[188:191], v[84:87]
    buffer_load_dwordx4 v[160:163], v236, s[48:51], s4 offen sc1
    v_mfma_f32_16x16x32_bf16 v[88:91], a[120:123], v[188:191], v[88:91]
    buffer_load_dwordx4 v[164:167], v236, s[48:51], s5 offen sc1
    ds_read_b128 v[104:107], v242 offset:8192
    v_mfma_f32_16x16x32_bf16 v[92:95], a[124:127], v[188:191], v[92:95]
    ds_read_b128 v[108:111], v242 offset:12288
    s_waitcnt vmcnt(7)
    v_mfma_f32_16x16x32_bf16 v[80:83], a[128:131], v[192:195], v[80:83]
    buffer_load_dwordx4 v[168:171], v236, s[48:51], s6 offen sc1
    v_mfma_f32_16x16x32_bf16 v[84:87], a[132:135], v[192:195], v[84:87]
    v_mfma_f32_16x16x32_bf16 v[88:91], a[136:139], v[192:195], v[88:91]
    buffer_load_dwordx4 v[172:175], v236, s[48:51], s7 offen sc1
    v_mfma_f32_16x16x32_bf16 v[92:95], a[140:143], v[192:195], v[92:95]
    s_waitcnt vmcnt(8)
    v_mfma_f32_16x16x32_bf16 v[80:83], a[144:147], v[196:199], v[80:83]
    buffer_load_dwordx4 v[176:179], v236, s[48:51], s8 offen sc1
    buffer_load_dwordx4 v[180:183], v236, s[48:51], s9 offen sc1
    v_mfma_f32_16x16x32_bf16 v[84:87], a[148:151], v[196:199], v[84:87]
    s_waitcnt lgkmcnt(2)
    v_add_f32 v96, v96, v100
    v_mfma_f32_16x16x32_bf16 v[88:91], a[152:155], v[196:199], v[88:91]
    v_add_f32 v97, v97, v101
    v_add_f32 v98, v98, v102
    v_mfma_f32_16x16x32_bf16 v[92:95], a[156:159], v[196:199], v[92:95]
    v_add_f32 v99, v99, v103
    s_waitcnt vmcnt(9)
    v_mfma_f32_16x16x32_bf16 v[80:83], a[160:163], v[200:203], v[80:83]
    buffer_load_dwordx4 v[184:187], v236, s[48:51], s10 offen sc1
    s_waitcnt lgkmcnt(0)
    v_add_f32 v104, v104, v108
    v_mfma_f32_16x16x32_bf16 v[84:87], a[164:167], v[200:203], v[84:87]
    v_add_f32 v105, v105, v109
    v_mfma_f32_16x16x32_bf16 v[88:91], a[168:171], v[200:203], v[88:91]
    v_add_f32 v106, v106, v110
    v_mfma_f32_16x16x32_bf16 v[92:95], a[172:175], v[200:203], v[92:95]
    v_add_f32 v107, v107, v111
    s_waitcnt vmcnt(9)
    v_mfma_f32_16x16x32_bf16 v[80:83], a[176:179], v[204:207], v[80:83]
    buffer_load_dwordx4 v[188:191], v236, s[48:51], s11 offen sc1
    v_add_f32 v96, v96, v56
    v_mfma_f32_16x16x32_bf16 v[84:87], a[180:183], v[204:207], v[84:87]
    v_add_f32 v97, v97, v57
    v_mfma_f32_16x16x32_bf16 v[88:91], a[184:187], v[204:207], v[88:91]
    v_add_f32 v98, v98, v58
    v_mfma_f32_16x16x32_bf16 v[92:95], a[188:191], v[204:207], v[92:95]
    v_add_f32 v99, v99, v59
    s_waitcnt vmcnt(9)
    v_mfma_f32_16x16x32_bf16 v[80:83], a[192:195], v[208:211], v[80:83]
    buffer_load_dwordx4 v[192:195], v236, s[48:51], s12 offen sc1
    v_add_f32 v96, v96, v104
    v_mfma_f32_16x16x32_bf16 v[84:87], a[196:199], v[208:211], v[84:87]
    v_add_f32 v97, v97, v105
    v_mfma_f32_16x16x32_bf16 v[88:91], a[200:203], v[208:211], v[88:91]
    v_add_f32 v98, v98, v106
    v_mfma_f32_16x16x32_bf16 v[92:95], a[204:207], v[208:211], v[92:95]
    v_add_f32 v99, v99, v107
    s_waitcnt vmcnt(9)
    v_mfma_f32_16x16x32_bf16 v[80:83], a[208:211], v[212:215], v[80:83]
    buffer_load_dwordx4 v[196:199], v236, s[48:51], s13 offen sc1
    v_mfma_f32_16x16x32_bf16 v[84:87], a[212:215], v[212:215], v[84:87]
    v_cvt_pk_bf16_f32 v116, v96, v97
    v_mfma_f32_16x16x32_bf16 v[88:91], a[216:219], v[212:215], v[88:91]
    v_cvt_pk_bf16_f32 v117, v98, v99
    v_mfma_f32_16x16x32_bf16 v[92:95], a[220:223], v[212:215], v[92:95]
    s_waitcnt vmcnt(9)
    v_mfma_f32_16x16x32_bf16 v[64:67], a[0:3], v[160:163], 0
    buffer_load_dwordx4 v[200:203], v236, s[48:51], s14 offen sc1
    v_mfma_f32_16x16x32_bf16 v[68:71], a[4:7], v[160:163], 0
    v_mfma_f32_16x16x32_bf16 v[72:75], a[8:11], v[160:163], 0
    v_mfma_f32_16x16x32_bf16 v[76:79], a[12:15], v[160:163], 0
    s_waitcnt vmcnt(9)
    v_mfma_f32_16x16x32_bf16 v[64:67], a[16:19], v[164:167], v[64:67]
    buffer_load_dwordx4 v[204:207], v236, s[48:51], s15 offen sc1
    v_mfma_f32_16x16x32_bf16 v[68:71], a[20:23], v[164:167], v[68:71]
    v_mfma_f32_16x16x32_bf16 v[72:75], a[24:27], v[164:167], v[72:75]
    ds_write_b128 v240, v[80:83] offset:16384
    v_mfma_f32_16x16x32_bf16 v[76:79], a[28:31], v[164:167], v[76:79]
    s_waitcnt vmcnt(9)
    v_mfma_f32_16x16x32_bf16 v[64:67], a[32:35], v[168:171], v[64:67]
    buffer_load_dwordx4 v[208:211], v236, s[48:51], s16 offen sc1
    v_mfma_f32_16x16x32_bf16 v[68:71], a[36:39], v[168:171], v[68:71]
    v_mfma_f32_16x16x32_bf16 v[72:75], a[40:43], v[168:171], v[72:75]
    ds_write_b128 v241, v[84:87] offset:16384
    v_mfma_f32_16x16x32_bf16 v[76:79], a[44:47], v[168:171], v[76:79]
    s_waitcnt vmcnt(9)
    v_mfma_f32_16x16x32_bf16 v[64:67], a[48:51], v[172:175], v[64:67]
    buffer_load_dwordx4 v[212:215], v237, s[48:51], s17 offen sc1
    v_mfma_f32_16x16x32_bf16 v[68:71], a[52:55], v[172:175], v[68:71]
    v_mfma_f32_16x16x32_bf16 v[72:75], a[56:59], v[172:175], v[72:75]
    ds_write_b128 v240, v[88:91] offset:16512
    v_mfma_f32_16x16x32_bf16 v[76:79], a[60:63], v[172:175], v[76:79]
    s_waitcnt vmcnt(9)
    v_mfma_f32_16x16x32_bf16 v[64:67], a[64:67], v[176:179], v[64:67]
    v_add_u32 v236, s93, v246
    v_mfma_f32_16x16x32_bf16 v[68:71], a[68:71], v[176:179], v[68:71]
    v_add_u32 v237, s93, v247
    v_mfma_f32_16x16x32_bf16 v[72:75], a[72:75], v[176:179], v[72:75]
    buffer_load_dwordx4 v[160:163], v236, s[48:51], s4 offen sc1
    v_mfma_f32_16x16x32_bf16 v[76:79], a[76:79], v[176:179], v[76:79]
    ds_write_b128 v241, v[92:95] offset:16512
    s_waitcnt vmcnt(9)
    v_mfma_f32_16x16x32_bf16 v[64:67], a[80:83], v[180:183], v[64:67]
    buffer_load_dwordx4 v[164:167], v236, s[48:51], s5 offen sc1
    v_mfma_f32_16x16x32_bf16 v[68:71], a[84:87], v[180:183], v[68:71]
    v_mfma_f32_16x16x32_bf16 v[72:75], a[88:91], v[180:183], v[72:75]
    v_mfma_f32_16x16x32_bf16 v[76:79], a[92:95], v[180:183], v[76:79]
    s_waitcnt vmcnt(9)
    v_mfma_f32_16x16x32_bf16 v[64:67], a[96:99], v[184:187], v[64:67]
    buffer_load_dwordx4 v[168:171], v236, s[48:51], s6 offen sc1
    v_mfma_f32_16x16x32_bf16 v[68:71], a[100:103], v[184:187], v[68:71]
    s_waitcnt lgkmcnt(0)
L_hpI11:
    s_cbranch_execz L_hpI_back0
    s_barrier
    v_mfma_f32_16x16x32_bf16 v[72:75], a[104:107], v[184:187], v[72:75]
    ds_read_b128 v[96:99], v242 offset:16384
    v_mfma_f32_16x16x32_bf16 v[76:79], a[108:111], v[184:187], v[76:79]
    ds_read_b128 v[100:103], v242 offset:20480
    s_waitcnt vmcnt(9)
    v_mfma_f32_16x16x32_bf16 v[64:67], a[112:115], v[188:191], v[64:67]
    buffer_load_dwordx4 v[172:175], v236, s[48:51], s7 offen sc1
    v_mfma_f32_16x16x32_bf16 v[68:71], a[116:119], v[188:191], v[68:71]
    ds_read_b128 v[104:107], v242 offset:24576
    v_mfma_f32_16x16x32_bf16 v[72:75], a[120:123], v[188:191], v[72:75]
    ds_read_b128 v[108:111], v242 offset:28672
    v_mfma_f32_16x16x32_bf16 v[76:79], a[124:127], v[188:191], v[76:79]
    s_waitcnt vmcnt(9)
    v_mfma_f32_16x16x32_bf16 v[64:67], a[128:131], v[192:195], v[64:67]
    buffer_load_dwordx4 v[176:179], v236, s[48:51], s8 offen sc1
    v_mfma_f32_16x16x32_bf16 v[68:71], a[132:135], v[192:195], v[68:71]
    v_mfma_f32_16x16x32_bf16 v[72:75], a[136:139], v[192:195], v[72:75]
    v_mfma_f32_16x16x32_bf16 v[76:79], a[140:143], v[192:195], v[76:79]
    s_waitcnt vmcnt(9)
    v_mfma_f32_16x16x32_bf16 v[64:67], a[144:147], v[196:199], v[64:67]
    buffer_load_dwordx4 v[180:183], v236, s[48:51], s9 offen sc1
    s_waitcnt lgkmcnt(2)
    v_add_f32 v96, v96, v100
    v_mfma_f32_16x16x32_bf16 v[68:71], a[148:151], v[196:199], v[68:71]
    v_add_f32 v97, v97, v101
    v_mfma_f32_16x16x32_bf16 v[72:75], a[152:155], v[196:199], v[72:75]
    v_add_f32 v98, v98, v102
    v_mfma_f32_16x16x32_bf16 v[76:79], a[156:159], v[196:199], v[76:79]
    v_add_f32 v99, v99, v103
    s_waitcnt vmcnt(9)
    v_mfma_f32_16x16x32_bf16 v[64:67], a[160:163], v[200:203], v[64:67]
    buffer_load_dwordx4 v[184:187], v236, s[48:51], s10 offen sc1
    s_waitcnt lgkmcnt(0)
    v_add_f32 v104, v104, v108
    v_mfma_f32_16x16x32_bf16 v[68:71], a[164:167], v[200:203], v[68:71]
    v_add_f32 v105, v105, v109
    v_mfma_f32_16x16x32_bf16 v[72:75], a[168:171], v[200:203], v[72:75]
    v_add_f32 v106, v106, v110
    v_mfma_f32_16x16x32_bf16 v[76:79], a[172:175], v[200:203], v[76:79]
    v_add_f32 v107, v107, v111
    s_waitcnt vmcnt(9)
    v_mfma_f32_16x16x32_bf16 v[64:67], a[176:179], v[204:207], v[64:67]
    buffer_load_dwordx4 v[188:191], v236, s[48:51], s11 offen sc1
    v_add_f32 v96, v96, v56
    v_mfma_f32_16x16x32_bf16 v[68:71], a[180:183], v[204:207], v[68:71]
    v_add_f32 v97, v97, v57
    v_mfma_f32_16x16x32_bf16 v[72:75], a[184:187], v[204:207], v[72:75]
    v_add_f32 v98, v98, v58
    v_mfma_f32_16x16x32_bf16 v[76:79], a[188:191], v[204:207], v[76:79]
    v_add_f32 v99, v99, v59
    s_waitcnt vmcnt(9)
    v_mfma_f32_16x16x32_bf16 v[64:67], a[192:195], v[208:211], v[64:67]
    buffer_load_dwordx4 v[192:195], v236, s[48:51], s12 offen sc1
    v_add_f32 v96, v96, v104
    v_mfma_f32_16x16x32_bf16 v[68:71], a[196:199], v[208:211], v[68:71]
    v_add_f32 v97, v97, v105
    v_mfma_f32_16x16x32_bf16 v[72:75], a[200:203], v[208:211], v[72:75]
    v_add_f32 v98, v98, v106
    v_mfma_f32_16x16x32_bf16 v[76:79], a[204:207], v[208:211], v[76:79]
    v_add_f32 v99, v99, v107
    s_waitcnt vmcnt(9)
    v_mfma_f32_16x16x32_bf16 v[64:67], a[208:211], v[212:215], v[64:67]
    buffer_load_dwordx4 v[196:199], v236, s[48:51], s13 offen sc1
    v_mfma_f32_16x16x32_bf16 v[68:71], a[212:215], v[212:215], v[68:71]
    v_cvt_pk_bf16_f32 v118, v96, v97
    v_mfma_f32_16x16x32_bf16 v[72:75], a[216:219], v[212:215], v[72:75]
    v_cvt_pk_bf16_f32 v119, v98, v99
    v_mfma_f32_16x16x32_bf16 v[76:79], a[220:223], v[212:215], v[76:79]
    s_waitcnt vmcnt(9)
    v_mfma_f32_16x16x32_bf16 v[80:83], a[0:3], v[160:163], 0
    buffer_load_dwordx4 v[200:203], v236, s[48:51], s14 offen sc1
    v_mfma_f32_16x16x32_bf16 v[84:87], a[4:7], v[160:163], 0
    v_mfma_f32_16x16x32_bf16 v[88:91], a[8:11], v[160:163], 0
    v_mfma_f32_16x16x32_bf16 v[92:95], a[12:15], v[160:163], 0
    s_waitcnt vmcnt(9)
    v_mfma_f32_16x16x32_bf16 v[80:83], a[16:19], v[164:167], v[80:83]
    buffer_load_dwordx4 v[204:207], v236, s[48:51], s15 offen sc1
    v_mfma_f32_16x16x32_bf16 v[84:87], a[20:23], v[164:167], v[84:87]
    v_mfma_f32_16x16x32_bf16 v[88:91], a[24:27], v[164:167], v[88:91]
    ds_write_b128 v240, v[64:67] offset:0
    v_mfma_f32_16x16x32_bf16 v[92:95], a[28:31], v[164:167], v[92:95]
    s_waitcnt vmcnt(9)
    v_mfma_f32_16x16x32_bf16 v[80:83], a[32:35], v[168:171], v[80:83]
    buffer_load_dwordx4 v[208:211], v236, s[48:51], s16 offen sc1
    v_mfma_f32_16x16x32_bf16 v[84:87], a[36:39], v[168:171], v[84:87]
    v_mfma_f32_16x16x32_bf16 v[88:91], a[40:43], v[168:171], v[88:91]
    ds_write_b128 v241, v[68:71] offset:0
    v_mfma_f32_16x16x32_bf16 v[92:95], a[44:47], v[168:171], v[92:95]
    s_waitcnt vmcnt(9)
    v_mfma_f32_16x16x32_bf16 v[80:83], a[48:51], v[172:175], v[80:83]
    buffer_load_dwordx4 v[212:215], v237, s[48:51], s17 offen sc1
    v_mfma_f32_16x16x32_bf16 v[84:87], a[52:55], v[172:175], v[84:87]
    v_mfma_f32_16x16x32_bf16 v[88:91], a[56:59], v[172:175], v[88:91]
    ds_write_b128 v240, v[72:75] offset:128
    v_mfma_f32_16x16x32_bf16 v[92:95], a[60:63], v[172:175], v[92:95]
    s_waitcnt vmcnt(9)
    v_mfma_f32_16x16x32_bf16 v[80:83], a[64:67], v[176:179], v[80:83]
    ds_write_b128 v241, v[76:79] offset:128
    v_mfma_f32_16x16x32_bf16 v[84:87], a[68:71], v[176:179], v[84:87]
    v_mfma_f32_16x16x32_bf16 v[88:91], a[72:75], v[176:179], v[88:91]
    buffer_store_dwordx2 v[112:113], v248, s[40:43], s94 offen sc1
    v_mfma_f32_16x16x32_bf16 v[92:95], a[76:79], v[176:179], v[92:95]
    s_waitcnt vmcnt(9)
    v_mfma_f32_16x16x32_bf16 v[80:83], a[80:83], v[180:183], v[80:83]
    buffer_store_dwordx2 v[114:115], v248, s[40:43], s95 offen sc1
    v_mfma_f32_16x16x32_bf16 v[84:87], a[84:87], v[180:183], v[84:87]
    v_mfma_f32_16x16x32_bf16 v[88:91], a[88:91], v[180:183], v[88:91]
    v_mfma_f32_16x16x32_bf16 v[92:95], a[92:95], v[180:183], v[92:95]
    s_waitcnt vmcnt(9)
    v_mfma_f32_16x16x32_bf16 v[80:83], a[96:99], v[184:187], v[80:83]
    s_waitcnt lgkmcnt(0)
    s_barrier
    v_mfma_f32_16x16x32_bf16 v[84:87], a[100:103], v[184:187], v[84:87]
    ds_read_b128 v[96:99], v242 offset:0
    v_mfma_f32_16x16x32_bf16 v[88:91], a[104:107], v[184:187], v[88:91]
    ds_read_b128 v[100:103], v242 offset:4096
    v_mfma_f32_16x16x32_bf16 v[92:95], a[108:111], v[184:187], v[92:95]
    buffer_store_dwordx2 v[116:117], v248, s[40:43], s96 offen sc1
    s_waitcnt vmcnt(9)
    v_mfma_f32_16x16x32_bf16 v[80:83], a[112:115], v[188:191], v[80:83]
    ds_read_b128 v[104:107], v242 offset:8192
    v_mfma_f32_16x16x32_bf16 v[84:87], a[116:119], v[188:191], v[84:87]
    ds_read_b128 v[108:111], v242 offset:12288
    v_mfma_f32_16x16x32_bf16 v[88:91], a[120:123], v[188:191], v[88:91]
    buffer_store_dwordx2 v[118:119], v248, s[40:43], s97 offen sc1
    v_mfma_f32_16x16x32_bf16 v[92:95], a[124:127], v[188:191], v[92:95]
    s_waitcnt vmcnt(9)
    v_mfma_f32_16x16x32_bf16 v[80:83], a[128:131], v[192:195], v[80:83]
    v_mfma_f32_16x16x32_bf16 v[84:87], a[132:135], v[192:195], v[84:87]
    v_mfma_f32_16x16x32_bf16 v[88:91], a[136:139], v[192:195], v[88:91]
    v_mfma_f32_16x16x32_bf16 v[92:95], a[140:143], v[192:195], v[92:95]
    s_waitcnt vmcnt(8)
    v_mfma_f32_16x16x32_bf16 v[80:83], a[144:147], v[196:199], v[80:83]
    s_waitcnt lgkmcnt(2)
    v_add_f32 v96, v96, v100
    v_mfma_f32_16x16x32_bf16 v[84:87], a[148:151], v[196:199], v[84:87]
    v_add_f32 v97, v97, v101
    v_mfma_f32_16x16x32_bf16 v[88:91], a[152:155], v[196:199], v[88:91]
    v_add_f32 v98, v98, v102
    v_mfma_f32_16x16x32_bf16 v[92:95], a[156:159], v[196:199], v[92:95]
    v_add_f32 v99, v99, v103
    s_waitcnt vmcnt(7)
    v_mfma_f32_16x16x32_bf16 v[80:83], a[160:163], v[200:203], v[80:83]
    s_waitcnt lgkmcnt(0)
    v_add_f32 v104, v104, v108
    v_mfma_f32_16x16x32_bf16 v[84:87], a[164:167], v[200:203], v[84:87]
    v_add_f32 v105, v105, v109
    v_mfma_f32_16x16x32_bf16 v[88:91], a[168:171], v[200:203], v[88:91]
    v_add_f32 v106, v106, v110
    v_mfma_f32_16x16x32_bf16 v[92:95], a[172:175], v[200:203], v[92:95]
    v_add_f32 v107, v107, v111
L_hpI12:
    s_cbranch_execz L_hpI_back0
    s_waitcnt vmcnt(6)
    v_mfma_f32_16x16x32_bf16 v[80:83], a[176:179], v[204:207], v[80:83]
    v_add_f32 v96, v96, v56
    v_mfma_f32_16x16x32_bf16 v[84:87], a[180:183], v[204:207], v[84:87]
    v_add_f32 v97, v97, v57
    v_mfma_f32_16x16x32_bf16 v[88:91], a[184:187], v[204:207], v[88:91]
    v_add_f32 v98, v98, v58
    v_mfma_f32_16x16x32_bf16 v[92:95], a[188:191], v[204:207], v[92:95]
    v_add_f32 v99, v99, v59
    s_waitcnt vmcnt(5)
    v_mfma_f32_16x16x32_bf16 v[80:83], a[192:195], v[208:211], v[80:83]
    v_add_f32 v96, v96, v104
    v_mfma_f32_16x16x32_bf16 v[84:87], a[196:199], v[208:211], v[84:87]
    v_add_f32 v97, v97, v105
    v_mfma_f32_16x16x32_bf16 v[88:91], a[200:203], v[208:211], v[88:91]
    v_add_f32 v98, v98, v106
    v_mfma_f32_16x16x32_bf16 v[92:95], a[204:207], v[208:211], v[92:95]
    v_add_f32 v99, v99, v107
    s_waitcnt vmcnt(4)
    v_mfma_f32_16x16x32_bf16 v[80:83], a[208:211], v[212:215], v[80:83]
    v_cvt_pk_bf16_f32 v120, v96, v97
    v_mfma_f32_16x16x32_bf16 v[84:87], a[212:215], v[212:215], v[84:87]
    v_cvt_pk_bf16_f32 v121, v98, v99
    v_mfma_f32_16x16x32_bf16 v[88:91], a[216:219], v[212:215], v[88:91]
    buffer_store_dwordx2 v[120:121], v248, s[40:43], s98 offen sc1
    v_mfma_f32_16x16x32_bf16 v[92:95], a[220:223], v[212:215], v[92:95]
    s_nop 1
    ds_write_b128 v240, v[80:83] offset:16384
    s_nop 0
    ds_write_b128 v241, v[84:87] offset:16384
    s_nop 0
    ds_write_b128 v240, v[88:91] offset:16512
    s_nop 0
    ds_write_b128 v241, v[92:95] offset:16512
    s_waitcnt lgkmcnt(0)
    s_barrier
    ds_read_b128 v[96:99], v242 offset:16384
    ds_read_b128 v[100:103], v242 offset:20480
    ds_read_b128 v[104:107], v242 offset:24576
    ds_read_b128 v[108:111], v242 offset:28672
L_hpI13:
    s_cbranch_execz L_hpI_back0
    s_waitcnt lgkmcnt(2)
    v_add_f32 v96, v96, v100
    v_add_f32 v97, v97, v101
    v_add_f32 v98, v98, v102
    v_add_f32 v99, v99, v103
    s_waitcnt lgkmcnt(0)
    v_add_f32 v104, v104, v108
    v_add_f32 v105, v105, v109
    v_add_f32 v106, v106, v110
    v_add_f32 v107, v107, v111
    v_add_f32 v96, v96, v56
    v_add_f32 v97, v97, v57
    v_add_f32 v98, v98, v58
    v_add_f32 v99, v99, v59
    v_add_f32 v96, v96, v104
    v_add_f32 v97, v97, v105
    v_add_f32 v98, v98, v106
    v_add_f32 v99, v99, v107
    v_cvt_pk_bf16_f32 v122, v96, v97
    v_cvt_pk_bf16_f32 v123, v98, v99
    buffer_store_dwordx2 v[122:123], v248, s[40:43], s99 offen sc1
L_fin:
    s_endpgm
.p2align 12
.section .rodata,"a"
.p2align 6
.amdhsa_kernel standalone__dense_activation_gelu__prompt_kernel
  .amdhsa_next_free_vgpr 512
  .amdhsa_next_free_sgpr 102
  .amdhsa_accum_offset 256
  .amdhsa_group_segment_fixed_size 0
  .amdhsa_kernarg_size 64
  .amdhsa_user_sgpr_count 2
  .amdhsa_user_sgpr_kernarg_segment_ptr 1
  .amdhsa_system_sgpr_workgroup_id_x 1
.end_amdhsa_kernel
```
